```python
import torch

def _softmax(x, axis=-1):
    return torch.softmax(x, dim=axis)
def _gelu(x):
    return torch.nn.functional.gelu(x, approximate="tanh")
def _silu(x):
    return torch.nn.functional.silu(x)
def _sigmoid(x):
    return torch.sigmoid(x)
def _layernorm(x, axis=-1, eps=1e-5):
    m = x.mean(dim=axis, keepdim=True)
    v = x.var(dim=axis, keepdim=True, unbiased=False)
    return (x - m) / torch.sqrt(v + eps)
def _scatter_add(tgt, idx, src, axis=0):
    return tgt.clone().index_add_(axis, idx, src)
def _segment_sum(src, seg, n):
    out = torch.zeros((n,) + src.shape[1:], dtype=src.dtype)
    return out.index_add_(0, seg, src)
def _pad(x, pw):
    flat = tuple(v for pair in reversed(pw) for v in pair)
    return torch.nn.functional.pad(x, flat)

kernel_name = 'concat_heads__grouped_kv_mqa__ssm_conv_s4d__prompt'

def setup_inputs():

    _w = (lambda a: (lambda t: t.to(torch.bfloat16) if t.is_floating_point() else t)(torch.as_tensor(a)))
    def _A_setup():
        B, S, D, H = 1, 2048, 512, 32
        Dh = D // H
        return {
            "x": _w((lambda *s: torch.randn(*s, dtype=torch.bfloat16) * 0.05)(B, S, D)),
            "wq": _w((lambda *s: torch.randn(*s, dtype=torch.bfloat16) * 0.8)(D, H * Dh)),
            "wk": _w((lambda *s: torch.randn(*s, dtype=torch.bfloat16) * 0.8)(D, Dh)),
            "wv": _w((lambda *s: torch.randn(*s, dtype=torch.bfloat16) * 0.05)(D, Dh)),
            "wo": _w((lambda *s: torch.randn(*s, dtype=torch.bfloat16) * 0.05)(H * Dh, D)),
        }
    _A_in = _A_setup()

    def _B_setup():
        Bsz, L, D, N = 1, 2048, 512, 128
        return {
            "u": _w((lambda *s: torch.randn(*s, dtype=torch.bfloat16) * 0.05)(Bsz, L, D)),
            "log_A_real": _w((lambda *s: torch.randn(*s, dtype=torch.bfloat16) * 6.4)(D, N) * 0.5),
            "A_imag": _w((lambda *s: torch.randn(*s, dtype=torch.bfloat16) * 0.05)(D, N) * 3.14),
            "C_real": _w((lambda *s: torch.randn(*s, dtype=torch.bfloat16) * 0.05)(D, N) / N ** 0.5),
            "C_imag": _w((lambda *s: torch.randn(*s, dtype=torch.bfloat16) * 0.05)(D, N) / N ** 0.5),
            "log_dt": _w((lambda *s: torch.randn(*s, dtype=torch.bfloat16) * 0.05)(D) * 0.5 - 4.0),
            "D_skip": _w((lambda *s: torch.randn(*s, dtype=torch.bfloat16) * 0.05)(D)),
        }
    _B_in = _B_setup()

    return {
        "A_x": _A_in["x"],
        "A_wq": _A_in["wq"],
        "A_wk": _A_in["wk"],
        "A_wv": _A_in["wv"],
        "A_wo": _A_in["wo"],
        "B_u": _B_in["u"],
        "B_log_A_real": _B_in["log_A_real"],
        "B_A_imag": _B_in["A_imag"],
        "B_C_real": _B_in["C_real"],
        "B_C_imag": _B_in["C_imag"],
        "B_log_dt": _B_in["log_dt"],
        "B_D_skip": _B_in["D_skip"],
    }

def reference(A_x, A_wq, A_wk, A_wv, A_wo, B_u, B_log_A_real, B_A_imag, B_C_real, B_C_imag, B_log_dt, B_D_skip):
    def _A_ref(x, wq, wk, wv, wo):
        B, S, D = x.shape
        H = 32
        Dh = D // H
        q = (lambda x, *d: x.permute(*d))((x @ wq).reshape(B, S, H, Dh), 0, 2, 1, 3)
        k = x @ wk
        v = x @ wv
        scores = torch.einsum("bhqd,bkd->bhqk", q, k) * (Dh ** -0.5)
        p = _softmax(scores, axis=-1)
        o = torch.einsum("bhqk,bkd->bhqd", p, v)
        return (lambda x, *d: x.permute(*d))(o, 0, 2, 1, 3).reshape(B, S, H * Dh) @ wo

    def _B_ref(u, log_A_real, A_imag, C_real, C_imag, log_dt, D_skip):
        L = u.shape[1]
        dt = torch.exp(log_dt)
        A = -torch.exp(log_A_real) + 1j * A_imag
        C = (C_real + 1j * C_imag) * dt[:, None]
        pos = (lambda x, dt: x.to(dt))(torch.arange(L), log_dt.dtype)
        P = torch.exp((A * dt[:, None])[:, :, None] * pos[None, None, :])
        K = 2.0 * torch.einsum("dn,dnl->dl", C, P).real
        L2 = 2 * L
        u_t = (lambda x, *d: x.permute(*d))(u, 0, 2, 1)
        Kf = (lambda x, *a, **k: torch.fft.rfft(x.float(), *a, **k))(K, L2)
        Uf = (lambda x, *a, **k: torch.fft.rfft(x.float(), *a, **k))(u_t, L2)
        y = (lambda x, *a, **k: torch.fft.irfft(x, *a, **k).to(torch.bfloat16))(Uf * Kf[None, :, :], L2)[:, :, :L]
        y = (lambda x, *d: x.permute(*d))(y, 0, 2, 1)
        return y + u * D_skip[None, None, :]

    a = _A_ref(A_x, A_wq, A_wk, A_wv, A_wo)
    b = _B_ref(B_u, B_log_A_real, B_A_imag, B_C_real, B_C_imag, B_log_dt, B_D_skip)
    return torch.concatenate([a, b], axis=-1)
```

```asm
; @launch grid=(256,1,1) block=(512,1,1) lds=163840
.amdgcn_target "amdgcn-amd-amdhsa--gfx950"
.text
.globl concat_heads__grouped_kv_mqa__ssm_conv_s4d__prompt_kernel
.p2align 12
.type concat_heads__grouped_kv_mqa__ssm_conv_s4d__prompt_kernel,@function
concat_heads__grouped_kv_mqa__ssm_conv_s4d__prompt_kernel:
    s_load_dwordx16 s[16:31], s[0:1], 0
    s_load_dwordx8 s[32:39], s[0:1], 64
    s_load_dwordx4 s[40:43], s[0:1], 96
    s_load_dwordx2 s[44:45], s[0:1], 112
    s_cmp_ge_u32 s2, 256
    s_cbranch_scc1 L_end
    v_lshrrev_b32 v1, 6, v0
    v_and_b32 v0, 63, v0
    v_readfirstlane_b32 s46, v1
    s_and_b32 s47, s2, 7
    s_lshr_b32 s48, s2, 3
    s_lshr_b32 s59, s2, 6
    s_lshl2_add_u32 s49, s47, s59
    s_and_b32 s50, s48, 7
    s_bfe_u32 s52, s46, 0x10001
    s_and_b32 s53, s46, 1
    v_lshlrev_b32 v5, 4, v0
    v_and_b32 v2, 15, v0
    v_lshrrev_b32 v3, 4, v0
    v_mov_b32 v1, 0
    s_mov_b32 s6, 0x10000000
    s_mov_b32 s7, 0x00020000
    s_mov_b32 s10, 0x200000
    s_mov_b32 s11, 0x00020000
    s_mov_b32 s15, 0x00020000
    s_cmp_ge_u32 s46, 4
    s_cbranch_scc1 L_X
    s_setprio 2
    s_mov_b64 exec, 0
    s_cmp_eq_u32 s46, 0
    s_cbranch_scc1 L_st400
L_tsr:
    s_mov_b64 exec, -1
    s_mov_b32 s60, 0x47000
    v_and_b32 v13, 1, v0
    v_mul_u32_u24 v13, 0xa9000, v13
    v_lshlrev_b32 v4, 10, v2
    v_lshl_add_u32 v4, v3, 4, v4
    s_and_b32 s54, s50, 1
    v_lshrrev_b32 v6, 1, v2
    v_xor_b32 v6, v6, v2
    v_bfe_u32 v6, v6, 2, s54
    v_mul_u32_u24 v6, 12288, v6
    v_xor_b32 v4, v4, v6
    s_lshr_b32 s54, s2, 4
    s_lshl4_add_u32 s54, s47, s54
    s_lshl_b32 s55, s54, 14
    s_lshl_b32 s56, s46, 8
    s_add_u32 s55, s55, s56
    s_lshl_b32 s56, s46, 12
    s_add_u32 s66, s56, 131072
    s_mov_b32 m0, s66
    s_movk_i32 s14, 0x4000
    s_lshl1_add_u32 s57, s49, s52
    s_lshl4_add_u32 s57, s57, s50
    s_lshl1_add_u32 s57, s57, s53
    s_xor_b32 s57, s57, 0x801
    s_lshl_b32 s64, s57, 10
    s_lshr_b32 s57, s50, 2
    s_xor_b32 s76, s47, 7
    s_lshl4_add_u32 s57, s57, s76
    s_mulk_i32 s57, 8704
    s_and_b32 s54, s54, 1
    s_lshl2_add_u32 s54, s59, s54
    s_lshl_b32 s54, s54, 8
    s_add_u32 s57, s57, s54
    s_add_u32 s74, s57, 4096
    s_bitcmp1_b32 s50, 0
    s_cselect_b32 s65, s74, s57
    s_waitcnt lgkmcnt(0)
    s_mov_b64 s[4:5], s[44:45]
    s_mov_b64 s[8:9], s[16:17]
    buffer_load_dwordx2 v[184:185], v13, s[4:7], s60 offen
    s_cselect_b64 s[12:13], s[22:23], s[20:21]
    buffer_load_dwordx4 v[192:195], v4, s[8:11], s55 offen offset:0
    buffer_load_dwordx4 v[196:199], v4, s[8:11], s55 offen offset:64
    buffer_load_dwordx4 v[200:203], v4, s[8:11], s55 offen offset:128
    buffer_load_dwordx4 v[204:207], v4, s[8:11], s55 offen offset:192
    buffer_load_dwordx4 v5, s[12:15], s56 offen offset:0 lds
    buffer_load_dwordx4 v5, s[12:15], s56 offen offset:1024 lds
    buffer_load_dwordx4 v5, s[12:15], s56 offen offset:2048 lds
    buffer_load_dwordx4 v5, s[12:15], s56 offen offset:3072 lds
    s_mov_b32 m0, 0x25200
    s_cbranch_scc1 L_A2
    buffer_load_dwordx4 v5, s[8:11], 0 offen lds
    s_branch L_A2
L_X:
    s_sub_u32 s63, s46, 4
    s_mov_b64 exec, 0
    s_cmp_eq_u32 s63, 0
    s_cbranch_scc1 L_st1000
    s_cmp_eq_u32 s63, 1
    s_cbranch_scc1 L_st840
    s_cmp_eq_u32 s63, 2
    s_cbranch_scc1 L_st1440
    s_cmp_eq_u32 s63, 3
    s_cbranch_scc1 L_stc80
L_t0r:
    s_mov_b64 exec, -1
    s_lshl_b32 s51, s47, 5
    s_add_u32 s51, s51, s48
    v_mov_b32 v4, 160256
    v_lshl_add_u32 v6, v2, 2, v4
    ds_write_b32 v6, v1
    s_lshl1_add_u32 s54, s51, s52
    s_lshl1_add_u32 s55, s54, s53
    s_lshl_b32 s55, s55, 7
    v_lshl_add_u32 v7, v0, 1, s55
    v_lshlrev_b32 v13, 1, s54
    v_lshl_add_u32 v8, s63, 2, v3
    v_xor_b32 v9, v2, v8
    v_lshlrev_b32 v9, 4, v9
    v_lshl_add_u32 v9, v8, 10, v9
    s_lshr_b32 s54, s50, 1
    s_add_u32 s54, s54, 1
    s_and_b32 s54, s54, 3
    v_lshl_add_u32 v200, s54, 14, v9
    s_add_u32 s54, s54, 1
    s_and_b32 s54, s54, 3
    v_lshl_add_u32 v201, s54, 14, v9
    s_add_u32 s54, s54, 1
    s_and_b32 s54, s54, 3
    v_lshl_add_u32 v202, s54, 14, v9
    v_lshrrev_b32 v8, 3, v0
    v_and_b32 v9, 7, v0
    v_and_b32 v14, 1, v3
    v_lshlrev_b32 v14, 2, v14
    v_xor_b32 v9, v9, v14
    v_lshlrev_b32 v9, 4, v9
    v_lshl_add_u32 v14, v8, 10, v9
    v_mov_b32 v3, 1
    s_mov_b32 s14, 0x80000
    s_lshl_b32 s64, s49, 16
    s_lshl_b32 s65, s63, 12
    s_lshl_b32 s66, s63, 15
    s_lshl_b32 s57, s50, 7
    s_add_u32 s66, s66, s57
    s_add_u32 s67, s49, s50
    s_waitcnt lgkmcnt(0)
    s_mov_b64 s[8:9], s[16:17]
    s_mov_b64 s[12:13], s[18:19]
    s_add_u32 m0, s65, 16384
    s_and_b32 s67, s67, 3
    s_lshl_b32 s72, s67, 17
    s_add_u32 s72, s72, s66
    global_load_ushort v17, v7, s[28:29]
    global_load_ushort v18, v7, s[30:31]
    global_load_ushort v19, v7, s[32:33]
    global_load_ushort v20, v7, s[34:35]
    global_load_ushort v16, v13, s[36:37]
    global_load_ushort v21, v13, s[38:39]
    buffer_load_dwordx4 v14, s[12:15], s72 offen offset:0 lds
    s_addk_i32 s72, 7168
    buffer_load_dwordx4 v14, s[12:15], s72 offen offset:1024 lds
    s_addk_i32 s72, 7168
    buffer_load_dwordx4 v14, s[12:15], s72 offen offset:2048 lds
    s_addk_i32 s72, 7168
    buffer_load_dwordx4 v14, s[12:15], s72 offen offset:3072 lds
    s_barrier
    s_add_u32 m0, s65, 0
    s_lshl_b32 s73, s67, 8
    s_add_u32 s73, s73, s64
    buffer_load_dwordx4 v200, s[8:11], s73 offen lds
    s_addk_i32 m0, 1024
    s_add_u32 s67, s67, 1
    buffer_load_dwordx4 v201, s[8:11], s73 offen lds
    s_addk_i32 m0, 1024
    s_and_b32 s67, s67, 3
    buffer_load_dwordx4 v202, s[8:11], s73 offen lds
    s_add_u32 m0, s65, 49152
    s_lshl_b32 s72, s67, 17
    s_add_u32 s72, s72, s66
    buffer_load_dwordx4 v14, s[12:15], s72 offen offset:0 lds
    s_addk_i32 s72, 7168
    buffer_load_dwordx4 v14, s[12:15], s72 offen offset:1024 lds
    s_addk_i32 s72, 7168
    buffer_load_dwordx4 v14, s[12:15], s72 offen offset:2048 lds
    v_and_b32 v228, 31, v0
    v_lshrrev_b32 v229, 5, v0
    v_and_b32 v230, 3, v0
    v_bfe_u32 v231, v0, 3, 1
    v_lshl_add_u32 v230, v231, 2, v230
    v_and_b32 v231, 4, v0
    v_cmp_ne_u32 vcc, 0, v231
    v_mov_b32 v232, 0x66678889
    v_mov_b32 v233, 0xccaa8885
    v_mov_b32 v234, 0xaa885550
    v_cndmask_b32 v232, 0, v232, vcc
    v_cndmask_b32 v233, v234, v233, vcc
    v_cmp_lt_u32 vcc, 15, v228
    v_lshlrev_b32 v234, 2, v230
    v_bfe_u32 v231, v0, 4, 1
    v_cndmask_b32 v232, v232, v233, vcc
L_st400:
    s_cbranch_execz L_tsr
    v_bfe_u32 v232, v232, v234, 4
    v_lshl_add_u32 v230, v231, 3, v230
    v_add3_u32 v232, v232, v230, 32
    s_mul_i32 s54, s52, 32640
    s_add_u32 s54, s54, 65536
    v_lshl_add_u32 v235, v229, 4, s54
    v_mov_b32 v236, 272
    v_mad_u32_u24 v204, v232, v236, v235
    v_mad_u32_u24 v206, v228, v236, v235
    s_mul_i32 s54, s63, 4160
    s_add_u32 s54, s54, 131136
    v_add_u32 v207, s54, v5
    s_add_u32 s54, s54, 4156
    v_lshlrev_b32 v230, 2, v2
    v_sub_u32 v230, s54, v230
    v_bfe_u32 v231, v0, 4, 1
    v_mul_u32_u24 v231, 4160, v231
    v_sub_u32 v208, v230, v231
    s_cmp_eq_u32 s53, 0
    s_mov_b32 s68, 0xaaaaaaaa
    s_mov_b32 s69, 0xaaaaaaaa
    s_cselect_b64 vcc, 1, 0
    v_and_b32 v230, 7, v0
    v_lshrrev_b32 v231, 3, v0
    v_lshlrev_b32 v8, 12, v230
    v_lshl_add_u32 v8, v231, 2, v8
    v_lshlrev_b32 v209, 13, v231
    v_lshl_add_u32 v209, v230, 4, v209
    v_mul_u32_u24 v230, 15872, v229
    v_add_u32 v211, v230, v5
    s_lshl_b32 s54, s63, 10
    s_sub_u32 s54, 47088, s54
    v_sub_u32 v210, s54, v5
    v_pk_mov_b32 v[224:225], 0, 0
    v_pk_mov_b32 v[226:227], 0, 0
    v_and_b32 v230, 1, v0
    v_xor_b32 v230, 1, v230
    v_mul_u32_u24 v230, 4158, v230
    v_lshl_add_u32 v230, v2, 1, v230
    v_and_b32 v232, 48, v0
    s_mul_i32 s54, s52, 8320
    s_lshl_b32 s55, s53, 6
    s_add_u32 s54, s54, s55
    s_add_u32 s54, s54, 131106
    v_add3_u32 v212, s54, v230, v232
    v_add_u32 v213, 1024, v212
    v_add_u32 v214, 2048, v212
    v_add_u32 v215, 3072, v212
    s_lshl_b32 s54, s52, 14
    s_add_u32 s54, s54, s55
    s_add_u32 s54, s54, 43488
    v_lshlrev_b32 v231, 5, v2
    v_sub_u32 v230, v232, v231
    v_add_u32 v216, s54, v230
    v_lshl_add_u32 v219, v2, 6, v232
    s_lshl_b32 s54, s63, 13
    v_add_u32 v217, s54, v5
    s_lshl_b32 s54, s63, 11
    v_add_u32 v218, s54, v5
    v_lshlrev_b32 v12, 2, v228
    v_lshl_add_u32 v12, v229, 13, v12
    v_lshlrev_b32 v221, 13, v228
    v_lshl_add_u32 v221, v229, 4, v221
    v_lshlrev_b32 v222, 7, v228
    v_bfe_u32 v230, v0, 2, 2
    v_bfe_u32 v232, v0, 4, 1
    v_bfe_u32 v233, v0, 1, 1
    v_lshl_add_u32 v232, v232, 1, v233
    v_bfe_u32 v233, v0, 3, 1
    v_xor_b32 v233, s53, v233
    v_lshl_add_u32 v232, v233, 2, v232
    v_lshlrev_b32 v232, 4, v232
    v_and_b32 v233, 1, v0
    v_lshl_add_u32 v232, v233, 3, v232
    v_lshl_add_u32 v231, v229, 2, v230
    v_lshl_add_u32 v6, v231, 7, v232
    v_lshlrev_b32 v9, 11, v228
    v_lshl_add_u32 v9, v229, 4, v9
    v_add_u32 v10, s65, v5
    v_xor_b32 v11, 0x1000, v10
    s_mov_b64 s[4:5], s[44:45]
    s_lshl4_add_u32 s54, s53, 8
    s_sub_u32 s54, s54, s47
    s_mulk_i32 s54, 17408
    s_lshl_b32 s55, s52, 11
    s_add_u32 s54, s54, s55
    s_add_u32 s70, s54, 0x60000
    s_add_u32 s71, s54, 0x61000
    s_add_u32 s74, s54, 0x62000
    s_add_u32 s75, s54, 0x63000
    s_lshl_b32 s54, s53, 14
    s_add_u32 s54, s54, s55
    s_bitset1_b32 s54, 15
    v_add_u32 v223, s54, v5
    s_lshl_b32 s77, s63, 9
    s_add_u32 s77, s77, 0x48000
    s_movk_i32 s62, 0x7fff
    s_movk_i32 s22, 2
    v_lshlrev_b32 v250, 3, v0
    s_add_u32 s54, s47, 1
    s_lshl_b32 s55, s53, 2
    s_xor_b32 s54, s54, s55
    s_lshl_b32 s55, s54, 4
    s_bfm_b64 s[20:21], 16, s55
    s_bitcmp1_b32 s54, 2
    s_cselect_b64 s[20:21], 0, s[20:21]
    s_waitcnt vmcnt(10)
    v_lshlrev_b32 v16, 16, v16
    v_lshlrev_b32 v17, 16, v17
    v_lshlrev_b32 v21, 16, v21
    v_lshlrev_b32 v18, 16, v18
    v_lshlrev_b32 v19, 16, v19
    v_lshlrev_b32 v20, 16, v20
    v_cndmask_b32 v220, 0, v21, vcc
    v_mul_f32 v16, 0x3fb8aa3b, v16
    v_mul_f32 v17, 0x3fb8aa3b, v17
    v_exp_f32 v16, v16
    v_exp_f32 v17, v17
    s_nop 0
    v_cvt_pk_bf16_f32 v17, v16, v17
    v_lshlrev_b32 v16, 16, v17
    v_and_b32 v17, 0xffff0000, v17
    v_mul_f32 v17, v17, v16
    v_mul_f32 v18, v18, v16
    v_mul_f32 v17, 0xbfb8aa3b, v17
    v_mul_f32 v18, 0x3e22f983, v18
    v_add_f32 v16, v16, v16
    v_mul_f32 v32, v19, v16
    v_mul_f32_e64 v33, -v20, v16
    v_mul_f32 v30, 0x41000000, v17
    v_mul_f32 v31, 0x41000000, v18
    v_exp_f32 v30, v30
    v_fract_f32 v31, v31
    v_cos_f32 v26, v31
    v_sin_f32 v27, v31
    s_nop 0
    v_pk_mul_f32 v[26:27], v[26:27], v[30:31] op_sel_hi:[1,0]
    v_exp_f32 v30, v17
    v_fract_f32 v31, v18
    v_cos_f32 v24, v31
    v_sin_f32 v25, v31
    s_nop 0
    v_pk_mul_f32 v[24:25], v[24:25], v[30:31] op_sel_hi:[1,0]
    v_mul_f32 v30, 0x43800000, v17
    v_mul_f32 v31, 0x43800000, v18
    v_exp_f32 v30, v30
    v_fract_f32 v31, v31
    v_cos_f32 v28, v31
    v_sin_f32 v29, v31
    s_nop 0
    v_pk_mul_f32 v[28:29], v[28:29], v[30:31] op_sel_hi:[1,0]
    v_mov_b32 v64, 0x3f80
    v_cvt_pk_bf16_f32 v96, v32, v33
    v_cvt_pk_bf16_f32 v65, v26, v27
    v_pk_mul_f32 v[50:51], v[26:27], v[26:27] op_sel_hi:[1,0]
    v_pk_mul_f32 v[34:35], v[32:33], v[24:25] op_sel_hi:[1,0]
    v_pk_fma_f32 v[50:51], v[26:27], v[26:27], v[50:51] op_sel:[1,1,0] op_sel_hi:[0,1,1] neg_lo:[0,1,0]
    v_pk_fma_f32 v[34:35], v[32:33], v[24:25], v[34:35] op_sel:[1,1,0] op_sel_hi:[0,1,1] neg_hi:[0,1,0]
    v_cvt_pk_bf16_f32 v66, v50, v51
    v_cvt_pk_bf16_f32 v97, v34, v35
    v_pk_mul_f32 v[52:53], v[50:51], v[26:27] op_sel_hi:[1,0]
    v_pk_mul_f32 v[36:37], v[34:35], v[24:25] op_sel_hi:[1,0]
    v_pk_fma_f32 v[52:53], v[50:51], v[26:27], v[52:53] op_sel:[1,1,0] op_sel_hi:[0,1,1] neg_lo:[0,1,0]
    v_pk_fma_f32 v[36:37], v[34:35], v[24:25], v[36:37] op_sel:[1,1,0] op_sel_hi:[0,1,1] neg_hi:[0,1,0]
    v_cvt_pk_bf16_f32 v67, v52, v53
    v_cvt_pk_bf16_f32 v98, v36, v37
    v_pk_mul_f32 v[50:51], v[52:53], v[26:27] op_sel_hi:[1,0]
    s_addk_i32 s72, 7168
    buffer_load_dwordx4 v14, s[12:15], s72 offen offset:3072 lds
    v_pk_mul_f32 v[38:39], v[36:37], v[24:25] op_sel_hi:[1,0]
    v_pk_fma_f32 v[50:51], v[52:53], v[26:27], v[50:51] op_sel:[1,1,0] op_sel_hi:[0,1,1] neg_lo:[0,1,0]
    v_pk_fma_f32 v[38:39], v[36:37], v[24:25], v[38:39] op_sel:[1,1,0] op_sel_hi:[0,1,1] neg_hi:[0,1,0]
    s_add_u32 m0, s65, 32768
    s_lshl_b32 s73, s67, 8
    s_add_u32 s73, s73, s64
    buffer_load_dwordx4 v200, s[8:11], s73 offen lds
    v_cvt_pk_bf16_f32 v68, v50, v51
    v_cvt_pk_bf16_f32 v99, v38, v39
    v_pk_mul_f32 v[52:53], v[50:51], v[26:27] op_sel_hi:[1,0]
    v_pk_mul_f32 v[40:41], v[38:39], v[24:25] op_sel_hi:[1,0]
    s_addk_i32 m0, 1024
    s_add_u32 s67, s67, 1
L_st840:
    s_cbranch_execz L_t0r
    buffer_load_dwordx4 v201, s[8:11], s73 offen lds
    v_pk_fma_f32 v[52:53], v[50:51], v[26:27], v[52:53] op_sel:[1,1,0] op_sel_hi:[0,1,1] neg_lo:[0,1,0]
    v_pk_fma_f32 v[40:41], v[38:39], v[24:25], v[40:41] op_sel:[1,1,0] op_sel_hi:[0,1,1] neg_hi:[0,1,0]
    v_cvt_pk_bf16_f32 v69, v52, v53
    v_cvt_pk_bf16_f32 v100, v40, v41
    s_addk_i32 m0, 1024
    s_and_b32 s67, s67, 3
    buffer_load_dwordx4 v202, s[8:11], s73 offen lds
    v_pk_mul_f32 v[50:51], v[52:53], v[26:27] op_sel_hi:[1,0]
    v_pk_mul_f32 v[42:43], v[40:41], v[24:25] op_sel_hi:[1,0]
    v_pk_fma_f32 v[50:51], v[52:53], v[26:27], v[50:51] op_sel:[1,1,0] op_sel_hi:[0,1,1] neg_lo:[0,1,0]
    s_add_u32 m0, s65, 81920
    s_lshl_b32 s72, s67, 17
    s_add_u32 s72, s72, s66
    buffer_load_dwordx4 v14, s[12:15], s72 offen offset:0 lds
    v_pk_fma_f32 v[42:43], v[40:41], v[24:25], v[42:43] op_sel:[1,1,0] op_sel_hi:[0,1,1] neg_hi:[0,1,0]
    v_cvt_pk_bf16_f32 v70, v50, v51
    v_cvt_pk_bf16_f32 v101, v42, v43
    v_pk_mul_f32 v[52:53], v[50:51], v[26:27] op_sel_hi:[1,0]
    s_addk_i32 s72, 7168
    buffer_load_dwordx4 v14, s[12:15], s72 offen offset:1024 lds
    v_pk_mul_f32 v[44:45], v[42:43], v[24:25] op_sel_hi:[1,0]
    v_pk_fma_f32 v[52:53], v[50:51], v[26:27], v[52:53] op_sel:[1,1,0] op_sel_hi:[0,1,1] neg_lo:[0,1,0]
    v_pk_fma_f32 v[44:45], v[42:43], v[24:25], v[44:45] op_sel:[1,1,0] op_sel_hi:[0,1,1] neg_hi:[0,1,0]
    v_cvt_pk_bf16_f32 v71, v52, v53
    s_addk_i32 s72, 7168
    buffer_load_dwordx4 v14, s[12:15], s72 offen offset:2048 lds
    s_waitcnt vmcnt(10)
    s_barrier
    v_cvt_pk_bf16_f32 v102, v44, v45
    v_pk_mul_f32 v[50:51], v[52:53], v[26:27] op_sel_hi:[1,0]
    v_pk_mul_f32 v[46:47], v[44:45], v[24:25] op_sel_hi:[1,0]
    s_addk_i32 s72, 7168
    buffer_load_dwordx4 v14, s[12:15], s72 offen offset:3072 lds
    v_pk_fma_f32 v[50:51], v[52:53], v[26:27], v[50:51] op_sel:[1,1,0] op_sel_hi:[0,1,1] neg_lo:[0,1,0]
    v_pk_fma_f32 v[46:47], v[44:45], v[24:25], v[46:47] op_sel:[1,1,0] op_sel_hi:[0,1,1] neg_hi:[0,1,0]
    v_cvt_pk_bf16_f32 v72, v50, v51
    v_cvt_pk_bf16_f32 v103, v46, v47
    s_add_u32 m0, s65, 65536
    s_lshl_b32 s73, s67, 8
    s_add_u32 s73, s73, s64
    buffer_load_dwordx4 v200, s[8:11], s73 offen lds
    v_pk_mul_f32 v[52:53], v[50:51], v[26:27] op_sel_hi:[1,0]
    v_pk_mul_f32 v[48:49], v[46:47], v[24:25] op_sel_hi:[1,0]
    v_pk_fma_f32 v[52:53], v[50:51], v[26:27], v[52:53] op_sel:[1,1,0] op_sel_hi:[0,1,1] neg_lo:[0,1,0]
    v_pk_fma_f32 v[48:49], v[46:47], v[24:25], v[48:49] op_sel:[1,1,0] op_sel_hi:[0,1,1] neg_hi:[0,1,0]
    s_addk_i32 m0, 1024
    s_add_u32 s67, s67, 1
    buffer_load_dwordx4 v201, s[8:11], s73 offen lds
    v_cvt_pk_bf16_f32 v73, v52, v53
    v_cvt_pk_bf16_f32 v104, v48, v49
    v_pk_mul_f32 v[50:51], v[52:53], v[26:27] op_sel_hi:[1,0]
    s_addk_i32 m0, 1024
    s_and_b32 s67, s67, 3
    buffer_load_dwordx4 v202, s[8:11], s73 offen lds
    v_pk_mul_f32 v[54:55], v[32:33], v[28:29] op_sel_hi:[1,0]
    v_pk_fma_f32 v[50:51], v[52:53], v[26:27], v[50:51] op_sel:[1,1,0] op_sel_hi:[0,1,1] neg_lo:[0,1,0]
    v_pk_fma_f32 v[54:55], v[32:33], v[28:29], v[54:55] op_sel:[1,1,0] op_sel_hi:[0,1,1] neg_hi:[0,1,0]
    v_cvt_pk_bf16_f32 v74, v50, v51
    s_add_u32 m0, s65, 114688
    s_lshl_b32 s72, s67, 17
    s_add_u32 s72, s72, s66
    buffer_load_dwordx4 v14, s[12:15], s72 offen offset:0 lds
    v_cvt_pk_bf16_f32 v105, v54, v55
    v_pk_mul_f32 v[52:53], v[50:51], v[26:27] op_sel_hi:[1,0]
    v_pk_mul_f32 v[34:35], v[36:37], v[28:29] op_sel_hi:[1,0]
    v_pk_fma_f32 v[52:53], v[50:51], v[26:27], v[52:53] op_sel:[1,1,0] op_sel_hi:[0,1,1] neg_lo:[0,1,0]
    s_addk_i32 s72, 7168
    buffer_load_dwordx4 v14, s[12:15], s72 offen offset:1024 lds
    v_pk_fma_f32 v[34:35], v[36:37], v[28:29], v[34:35] op_sel:[1,1,0] op_sel_hi:[0,1,1] neg_hi:[0,1,0]
    v_cvt_pk_bf16_f32 v75, v52, v53
    v_cvt_pk_bf16_f32 v106, v34, v35
    s_addk_i32 s72, 7168
    buffer_load_dwordx4 v14, s[12:15], s72 offen offset:2048 lds
    v_pk_mul_f32 v[50:51], v[52:53], v[26:27] op_sel_hi:[1,0]
    v_pk_mul_f32 v[56:57], v[40:41], v[28:29] op_sel_hi:[1,0]
    v_pk_fma_f32 v[50:51], v[52:53], v[26:27], v[50:51] op_sel:[1,1,0] op_sel_hi:[0,1,1] neg_lo:[0,1,0]
    v_pk_fma_f32 v[56:57], v[40:41], v[28:29], v[56:57] op_sel:[1,1,0] op_sel_hi:[0,1,1] neg_hi:[0,1,0]
    s_addk_i32 s72, 7168
    buffer_load_dwordx4 v14, s[12:15], s72 offen offset:3072 lds
    v_cvt_pk_bf16_f32 v76, v50, v51
    v_cvt_pk_bf16_f32 v107, v56, v57
    v_pk_mul_f32 v[52:53], v[50:51], v[26:27] op_sel_hi:[1,0]
    v_pk_mul_f32 v[38:39], v[44:45], v[28:29] op_sel_hi:[1,0]
    s_add_u32 m0, s65, 98304
    s_lshl_b32 s73, s67, 8
    s_add_u32 s73, s73, s64
    buffer_load_dwordx4 v200, s[8:11], s73 offen lds
    v_pk_fma_f32 v[52:53], v[50:51], v[26:27], v[52:53] op_sel:[1,1,0] op_sel_hi:[0,1,1] neg_lo:[0,1,0]
    v_pk_fma_f32 v[38:39], v[44:45], v[28:29], v[38:39] op_sel:[1,1,0] op_sel_hi:[0,1,1] neg_hi:[0,1,0]
    v_cvt_pk_bf16_f32 v77, v52, v53
    s_addk_i32 m0, 1024
    s_add_u32 s67, s67, 1
    buffer_load_dwordx4 v201, s[8:11], s73 offen lds
    v_cvt_pk_bf16_f32 v108, v38, v39
    v_pk_mul_f32 v[50:51], v[52:53], v[26:27] op_sel_hi:[1,0]
    v_pk_mul_f32 v[58:59], v[48:49], v[28:29] op_sel_hi:[1,0]
    v_pk_fma_f32 v[50:51], v[52:53], v[26:27], v[50:51] op_sel:[1,1,0] op_sel_hi:[0,1,1] neg_lo:[0,1,0]
    s_addk_i32 m0, 1024
    s_and_b32 s67, s67, 3
    buffer_load_dwordx4 v202, s[8:11], s73 offen lds
    s_waitcnt vmcnt(14)
    s_barrier
    ds_read_b64 v[22:23], v4 offset:32
    v_pk_fma_f32 v[58:59], v[48:49], v[28:29], v[58:59] op_sel:[1,1,0] op_sel_hi:[0,1,1] neg_hi:[0,1,0]
    v_cvt_pk_bf16_f32 v78, v50, v51
    v_cvt_pk_bf16_f32 v109, v58, v59
    v_pk_mul_f32 v[52:53], v[50:51], v[26:27] op_sel_hi:[1,0]
    v_pk_mul_f32 v[32:33], v[54:55], v[28:29] op_sel_hi:[1,0]
    v_pk_fma_f32 v[52:53], v[50:51], v[26:27], v[52:53] op_sel:[1,1,0] op_sel_hi:[0,1,1] neg_lo:[0,1,0]
    v_pk_fma_f32 v[32:33], v[54:55], v[28:29], v[32:33] op_sel:[1,1,0] op_sel_hi:[0,1,1] neg_hi:[0,1,0]
    v_cvt_pk_bf16_f32 v79, v52, v53
    v_cvt_pk_bf16_f32 v110, v32, v33
    v_pk_mul_f32 v[50:51], v[52:53], v[26:27] op_sel_hi:[1,0]
    v_pk_mul_f32 v[40:41], v[56:57], v[28:29] op_sel_hi:[1,0]
    v_pk_fma_f32 v[50:51], v[52:53], v[26:27], v[50:51] op_sel:[1,1,0] op_sel_hi:[0,1,1] neg_lo:[0,1,0]
    v_pk_fma_f32 v[40:41], v[56:57], v[28:29], v[40:41] op_sel:[1,1,0] op_sel_hi:[0,1,1] neg_hi:[0,1,0]
    v_cvt_pk_bf16_f32 v80, v50, v51
    v_cvt_pk_bf16_f32 v111, v40, v41
    buffer_load_dwordx4 v[128:131], v5, s[4:7], s70 offen offset:0 sc1
    v_pk_mul_f32 v[52:53], v[50:51], v[26:27] op_sel_hi:[1,0]
    v_pk_mul_f32 v[48:49], v[58:59], v[28:29] op_sel_hi:[1,0]
    buffer_load_dwordx4 v[132:135], v5, s[4:7], s70 offen offset:1024 sc1
    v_pk_fma_f32 v[52:53], v[50:51], v[26:27], v[52:53] op_sel:[1,1,0] op_sel_hi:[0,1,1] neg_lo:[0,1,0]
    v_pk_fma_f32 v[48:49], v[58:59], v[28:29], v[48:49] op_sel:[1,1,0] op_sel_hi:[0,1,1] neg_hi:[0,1,0]
    buffer_load_dwordx4 v[136:139], v5, s[4:7], s71 offen offset:0 sc1
    v_cvt_pk_bf16_f32 v81, v52, v53
    v_cvt_pk_bf16_f32 v112, v48, v49
    buffer_load_dwordx4 v[140:143], v5, s[4:7], s71 offen offset:1024 sc1
    v_pk_mul_f32 v[50:51], v[52:53], v[26:27] op_sel_hi:[1,0]
    v_pk_mul_f32 v[54:55], v[32:33], v[28:29] op_sel_hi:[1,0]
    v_pk_fma_f32 v[50:51], v[52:53], v[26:27], v[50:51] op_sel:[1,1,0] op_sel_hi:[0,1,1] neg_lo:[0,1,0]
    v_pk_fma_f32 v[54:55], v[32:33], v[28:29], v[54:55] op_sel:[1,1,0] op_sel_hi:[0,1,1] neg_hi:[0,1,0]
    v_cvt_pk_bf16_f32 v82, v50, v51
    v_cvt_pk_bf16_f32 v113, v54, v55
    v_pk_mul_f32 v[52:53], v[50:51], v[26:27] op_sel_hi:[1,0]
    v_pk_mul_f32 v[56:57], v[40:41], v[28:29] op_sel_hi:[1,0]
    v_pk_fma_f32 v[52:53], v[50:51], v[26:27], v[52:53] op_sel:[1,1,0] op_sel_hi:[0,1,1] neg_lo:[0,1,0]
    s_waitcnt vmcnt(11)
    s_barrier
    v_pk_fma_f32 v[56:57], v[40:41], v[28:29], v[56:57] op_sel:[1,1,0] op_sel_hi:[0,1,1] neg_hi:[0,1,0]
    buffer_load_dwordx4 v[144:147], v5, s[4:7], s74 offen offset:0 sc1
    v_cvt_pk_bf16_f32 v83, v52, v53
    v_cvt_pk_bf16_f32 v114, v56, v57
    buffer_load_dwordx4 v[148:151], v5, s[4:7], s74 offen offset:1024 sc1
    v_pk_mul_f32 v[50:51], v[52:53], v[26:27] op_sel_hi:[1,0]
    v_pk_mul_f32 v[58:59], v[48:49], v[28:29] op_sel_hi:[1,0]
    buffer_load_dwordx4 v[152:155], v5, s[4:7], s75 offen offset:0 sc1
    v_pk_fma_f32 v[50:51], v[52:53], v[26:27], v[50:51] op_sel:[1,1,0] op_sel_hi:[0,1,1] neg_lo:[0,1,0]
    v_pk_fma_f32 v[58:59], v[48:49], v[28:29], v[58:59] op_sel:[1,1,0] op_sel_hi:[0,1,1] neg_hi:[0,1,0]
    buffer_load_dwordx4 v[156:159], v5, s[4:7], s75 offen offset:1024 sc1
L_stc80:
    s_cbranch_execz L_t0r
    v_cvt_pk_bf16_f32 v84, v50, v51
    v_cvt_pk_bf16_f32 v115, v58, v59
    v_pk_mul_f32 v[52:53], v[50:51], v[26:27] op_sel_hi:[1,0]
    v_pk_mul_f32 v[32:33], v[54:55], v[28:29] op_sel_hi:[1,0]
    v_pk_fma_f32 v[52:53], v[50:51], v[26:27], v[52:53] op_sel:[1,1,0] op_sel_hi:[0,1,1] neg_lo:[0,1,0]
    v_pk_fma_f32 v[32:33], v[54:55], v[28:29], v[32:33] op_sel:[1,1,0] op_sel_hi:[0,1,1] neg_hi:[0,1,0]
    v_cvt_pk_bf16_f32 v85, v52, v53
    v_cvt_pk_bf16_f32 v116, v32, v33
    s_waitcnt vmcnt(8)
    s_barrier
    v_pk_mul_f32 v[50:51], v[52:53], v[26:27] op_sel_hi:[1,0]
    s_waitcnt vmcnt(4) lgkmcnt(0)
L_tw:
    ds_write_b128 v223, v[130:133] offset:0
    ds_write_b128 v223, v[138:141] offset:1024
    v_bitop3_b32 v128, v128, v134, v22 bitop3:0x7e
    v_bitop3_b32 v129, v129, v135, v23 bitop3:0x7e
    v_bitop3_b32 v136, v136, v142, v22 bitop3:0x7e
    v_bitop3_b32 v137, v137, v143, v23 bitop3:0x7e
    v_or3_b32 v128, v128, v129, v136
    v_or_b32 v128, v128, v137
    v_cmp_ne_u32 s[72:73], 0, v128
    s_cmp_lg_u64 s[72:73], 0
    s_cbranch_scc0 L_tok
    s_waitcnt lgkmcnt(0)
    buffer_load_dwordx4 v[128:131], v5, s[4:7], s70 offen offset:0 sc1
    buffer_load_dwordx4 v[132:135], v5, s[4:7], s70 offen offset:1024 sc1
    buffer_load_dwordx4 v[136:139], v5, s[4:7], s71 offen offset:0 sc1
    buffer_load_dwordx4 v[140:143], v5, s[4:7], s71 offen offset:1024 sc1
    s_sub_u32 s22, s22, 1
    s_cmp_lt_i32 s22, 0
    s_waitcnt vmcnt(0)
    s_cbranch_scc0 L_tw
    ds_write_b32 v4, v3 offset:8
L_tok:
    s_setprio 3
    s_waitcnt lgkmcnt(0)
    s_barrier
    v_pk_mul_f32 v[48:49], v[58:59], v[28:29] op_sel_hi:[1,0]
    v_pk_fma_f32 v[50:51], v[52:53], v[26:27], v[50:51] op_sel:[1,1,0] op_sel_hi:[0,1,1] neg_lo:[0,1,0]
    v_pk_fma_f32 v[48:49], v[58:59], v[28:29], v[48:49] op_sel:[1,1,0] op_sel_hi:[0,1,1] neg_hi:[0,1,0]
    v_cvt_pk_bf16_f32 v86, v50, v51
    v_cvt_pk_bf16_f32 v117, v48, v49
    v_pk_mul_f32 v[52:53], v[50:51], v[26:27] op_sel_hi:[1,0]
    v_pk_mul_f32 v[54:55], v[32:33], v[28:29] op_sel_hi:[1,0]
    buffer_load_dwordx2 v[248:249], v250, s[4:7], s77 offen sc1
    v_pk_fma_f32 v[52:53], v[50:51], v[26:27], v[52:53] op_sel:[1,1,0] op_sel_hi:[0,1,1] neg_lo:[0,1,0]
    v_pk_fma_f32 v[54:55], v[32:33], v[28:29], v[54:55] op_sel:[1,1,0] op_sel_hi:[0,1,1] neg_hi:[0,1,0]
    v_cvt_pk_bf16_f32 v87, v52, v53
    v_cvt_pk_bf16_f32 v118, v54, v55
    v_pk_mul_f32 v[50:51], v[52:53], v[26:27] op_sel_hi:[1,0]
    v_pk_mul_f32 v[58:59], v[48:49], v[28:29] op_sel_hi:[1,0]
    v_pk_fma_f32 v[50:51], v[52:53], v[26:27], v[50:51] op_sel:[1,1,0] op_sel_hi:[0,1,1] neg_lo:[0,1,0]
    v_pk_fma_f32 v[58:59], v[48:49], v[28:29], v[58:59] op_sel:[1,1,0] op_sel_hi:[0,1,1] neg_hi:[0,1,0]
    v_cvt_pk_bf16_f32 v88, v50, v51
    v_cvt_pk_bf16_f32 v119, v58, v59
    v_pk_mul_f32 v[52:53], v[50:51], v[26:27] op_sel_hi:[1,0]
    v_pk_mul_f32 v[32:33], v[54:55], v[28:29] op_sel_hi:[1,0]
    v_pk_fma_f32 v[52:53], v[50:51], v[26:27], v[52:53] op_sel:[1,1,0] op_sel_hi:[0,1,1] neg_lo:[0,1,0]
    v_pk_fma_f32 v[32:33], v[54:55], v[28:29], v[32:33] op_sel:[1,1,0] op_sel_hi:[0,1,1] neg_hi:[0,1,0]
    v_cvt_pk_bf16_f32 v89, v52, v53
    v_cvt_pk_bf16_f32 v120, v32, v33
    v_pk_mul_f32 v[50:51], v[52:53], v[26:27] op_sel_hi:[1,0]
    v_pk_mul_f32 v[48:49], v[58:59], v[28:29] op_sel_hi:[1,0]
    v_pk_fma_f32 v[50:51], v[52:53], v[26:27], v[50:51] op_sel:[1,1,0] op_sel_hi:[0,1,1] neg_lo:[0,1,0]
    s_waitcnt vmcnt(1) lgkmcnt(0)
    ds_write_b128 v223, v[146:149] offset:4096
    ds_write_b128 v223, v[154:157] offset:5120
    v_bitop3_b32 v144, v144, v150, v22 bitop3:0x7e
    v_bitop3_b32 v145, v145, v151, v23 bitop3:0x7e
    v_bitop3_b32 v152, v152, v158, v22 bitop3:0x7e
    v_bitop3_b32 v153, v153, v159, v23 bitop3:0x7e
    v_or3_b32 v144, v144, v145, v152
    v_or_b32 v144, v144, v153
    v_cmp_ne_u32 s[72:73], 0, v144
    s_cmp_lg_u64 s[72:73], 0
    s_cselect_b32 s72, 17, 1
L_fw:
    s_waitcnt vmcnt(0)
    v_cmp_ne_u64 s[70:71], v[22:23], v[248:249]
    v_mov_b32 v144, s72
    s_and_b64 s[22:23], s[70:71], s[20:21]
    s_cbranch_scc1 L_fr
L_fk:
    s_cmp_eq_u64 s[70:71], 0
    s_cselect_b32 s22, 1, 0
    v_lshl_add_u32 v144, s22, 8, v144
    s_mov_b64 exec, 1
    ds_add_u32 v4, v144 offset:16
    s_mov_b64 exec, -1
    s_mov_b64 exec, 0
    s_cmp_eq_u32 s63, 2
    s_cbranch_scc1 L_st3000
L_tzr:
    s_mov_b64 exec, -1
    v_pk_fma_f32 v[48:49], v[58:59], v[28:29], v[48:49] op_sel:[1,1,0] op_sel_hi:[0,1,1] neg_hi:[0,1,0]
    v_cvt_pk_bf16_f32 v90, v50, v51
    v_cvt_pk_bf16_f32 v121, v48, v49
    v_pk_mul_f32 v[52:53], v[50:51], v[26:27] op_sel_hi:[1,0]
    v_pk_mul_f32 v[54:55], v[32:33], v[28:29] op_sel_hi:[1,0]
    v_pk_fma_f32 v[52:53], v[50:51], v[26:27], v[52:53] op_sel:[1,1,0] op_sel_hi:[0,1,1] neg_lo:[0,1,0]
    v_pk_fma_f32 v[54:55], v[32:33], v[28:29], v[54:55] op_sel:[1,1,0] op_sel_hi:[0,1,1] neg_hi:[0,1,0]
    v_cvt_pk_bf16_f32 v91, v52, v53
    v_cvt_pk_bf16_f32 v122, v54, v55
    v_pk_mul_f32 v[50:51], v[52:53], v[26:27] op_sel_hi:[1,0]
    v_pk_mul_f32 v[58:59], v[48:49], v[28:29] op_sel_hi:[1,0]
    v_pk_fma_f32 v[50:51], v[52:53], v[26:27], v[50:51] op_sel:[1,1,0] op_sel_hi:[0,1,1] neg_lo:[0,1,0]
    v_pk_fma_f32 v[58:59], v[48:49], v[28:29], v[58:59] op_sel:[1,1,0] op_sel_hi:[0,1,1] neg_hi:[0,1,0]
    v_cvt_pk_bf16_f32 v92, v50, v51
    v_cvt_pk_bf16_f32 v123, v58, v59
    v_pk_mul_f32 v[52:53], v[50:51], v[26:27] op_sel_hi:[1,0]
    v_pk_fma_f32 v[52:53], v[50:51], v[26:27], v[52:53] op_sel:[1,1,0] op_sel_hi:[0,1,1] neg_lo:[0,1,0]
    v_cvt_pk_bf16_f32 v93, v52, v53
    v_pk_mul_f32 v[50:51], v[52:53], v[26:27] op_sel_hi:[1,0]
    v_pk_fma_f32 v[50:51], v[52:53], v[26:27], v[50:51] op_sel:[1,1,0] op_sel_hi:[0,1,1] neg_lo:[0,1,0]
    v_cvt_pk_bf16_f32 v94, v50, v51
    v_pk_mul_f32 v[52:53], v[50:51], v[26:27] op_sel_hi:[1,0]
    v_pk_fma_f32 v[52:53], v[50:51], v[26:27], v[52:53] op_sel:[1,1,0] op_sel_hi:[0,1,1] neg_lo:[0,1,0]
    v_cvt_pk_bf16_f32 v95, v52, v53
    s_branch L_X2
L_fr:
    s_sleep 2
    buffer_load_dwordx2 v[248:249], v250, s[4:7], s77 offen sc1
    s_sub_u32 s62, s62, 1
    s_cbranch_scc0 L_fw
    s_branch L_fk
    .p2align 12
L_A2:
L_st1000:
    s_cbranch_execz L_t0r
    v_lshlrev_b32 v6, 3, v2
    v_lshl_add_u32 v6, v3, 8, v6
    v_add_u32 v6, s66, v6
    s_bitcmp1_b32 s50, 0
    s_mov_b32 s72, 0x3eb8aa3b
    s_cselect_b32 s72, 1.0, s72
    s_mov_b32 s73, s72
    v_and_b32 v7, 1, v3
    v_lshlrev_b32 v7, 9, v7
    v_lshl_add_u32 v7, v2, 4, v7
    v_lshrrev_b32 v16, 1, v3
    v_lshl_add_u32 v7, v16, 3, v7
    v_lshlrev_b32 v10, 9, v3
    v_lshl_add_u32 v10, v2, 4, v10
    s_and_b32 s56, s50, 2
    s_lshl_b32 s34, s56, 7
    s_and_b32 s56, s50, 1
    s_and_b32 s57, s49, 2
    s_or_b32 s56, s56, s57
    s_and_b32 s57, s49, 1
    s_lshl1_add_u32 s56, s56, s57
    s_lshl_b32 s56, s56, 11
    s_add_u32 s34, s34, s56
    s_lshr_b32 s56, s50, 2
    s_lshl4_add_u32 s56, s56, s76
    s_mulk_i32 s56, 17408
    s_add_u32 s34, s34, s56
    s_add_u32 s34, s34, 0x64400
    s_add_u32 s56, s49, s50
    s_sub_u32 s56, s46, s56
    s_and_b32 s56, s56, 3
    s_lshl_b32 s56, s56, 15
    s_addk_i32 s56, 3072
    v_lshrrev_b32 v8, 6, v4
    v_and_b32 v37, 0x3030, v4
    v_xor_b32 v37, v37, v8
    v_and_b32 v8, 48, v8
    v_lshl_add_u32 v8, v8, 4, s56
    v_add_u32 v8, v8, v37
    v_xor_b32 v37, 64, v8
    v_xor_b32 v38, 128, v8
    v_xor_b32 v39, 192, v8
    v_mov_b32 v4, 160256
    s_lshl_b32 s56, s46, 10
    s_add_u32 s56, s56, 147968
    v_add_u32 v14, s56, v5
    v_add_u32 v15, 147968, v5
    s_lshl_b32 s56, s46, 8
    s_bitset1_b32 s56, 17
    v_lshl_add_u32 v11, v3, 4, s56
    v_mov_b32 v25, 1
    v_mov_b32 v36, 0x3f803f80
    s_lshr_b32 s56, s50, 2
    s_lshl_b32 s56, s56, 7
    s_lshl2_add_u32 s56, s49, s56
    s_and_b32 s57, s50, 3
    s_add_u32 s56, s56, s57
    s_lshl_b32 s56, s56, 3
    s_add_u32 s75, s56, 0x48000
    s_movk_i32 s77, 8704
    s_mov_b32 s37, 60928
    s_mov_b32 s63, 52224
    s_add_u32 s58, s65, 69632
    s_mov_b32 s28, 0xffff
    s_mov_b32 s29, 0xffff
    s_mov_b32 s62, 65536
    v_and_b32 v16, 31, v0
    v_lshrrev_b32 v17, 5, v0
    v_xor_b32 v18, v17, v2
    v_lshlrev_b32 v18, 4, v18
    s_lshr_b32 s59, s50, 1
    s_not_b32 s59, s59
    s_lshl1_add_u32 s59, s52, s59
    v_lshrrev_b32 v19, 4, v16
    v_add_lshl_u32 v19, v19, s59, 2
    v_and_b32 v20, 12, v0
    v_bfi_b32 v19, 12, v19, v2
    v_lshl_add_u32 v18, v20, 10, v18
    v_lshl_add_u32 v48, v19, 8, v18
    v_xor_b32 v49, 0x20, v48
    v_xor_b32 v50, 0x40, v48
    v_xor_b32 v51, 0x60, v48
    v_xor_b32 v52, 0x80, v48
    v_xor_b32 v53, 0xa0, v48
    v_xor_b32 v54, 0xc0, v48
    v_xor_b32 v55, 0xe0, v48
    v_xor_b32 v56, 0x10000, v48
    v_xor_b32 v57, 0x10020, v48
    v_xor_b32 v58, 0x10040, v48
    v_xor_b32 v59, 0x10060, v48
    v_xor_b32 v60, 0x10080, v48
    v_xor_b32 v61, 0x100a0, v48
    v_xor_b32 v62, 0x100c0, v48
    v_xor_b32 v63, 0x100e0, v48
    v_bfe_u32 v19, v0, 2, 2
    v_lshl_add_u32 v20, v17, 3, v19
    v_bfe_u32 v21, v0, 4, 1
    v_bfe_u32 v22, v0, 1, 1
    v_lshl_add_u32 v21, v21, 1, v22
    v_bfe_u32 v22, v0, 3, 1
    v_xor_b32 v22, s53, v22
    v_lshl_add_u32 v21, v22, 2, v21
    v_lshlrev_b32 v21, 4, v21
    v_and_b32 v22, 1, v0
    v_lshl_add_u32 v21, v22, 3, v21
    v_lshl_add_u32 v26, v20, 7, v21
    v_add_u32 v27, 0x10000, v26
    s_lshl4_add_u32 s76, s53, s76
    s_add_u32 s76, s76, 1
    s_mulk_i32 s76, 8704
    v_and_b32 v20, 27, v16
    v_cmp_eq_u32 vcc, 16, v20
    v_add_u32 v3, s76, v5
    v_add_u32 v2, 0x1000, v3
    v_cndmask_b32 v90, 0, v36, vcc
    v_cndmask_b32 v91, 0, v36, vcc
    v_mov_b64 v[92:93], v[90:91]
    v_mov_b64 v[98:99], v[90:91]
    v_mov_b64 v[100:101], v[90:91]
    v_mov_b64 v[114:115], v[90:91]
    v_mov_b64 v[116:117], v[90:91]
    v_mov_b64 v[122:123], v[90:91]
    v_mov_b64 v[124:125], v[90:91]
    s_mov_b64 exec, 0
    s_cmp_eq_u32 s46, 0
    s_cbranch_scc1 L_st1840
L_tar:
    s_mov_b64 exec, -1
    s_barrier
    s_waitcnt vmcnt(8)
    v_readlane_b32 s60, v184, 0
    v_readlane_b32 s42, v184, 1
    v_readlane_b32 s61, v185, 0
    v_readlane_b32 s43, v185, 1
    s_add_u32 s60, s60, s42
    s_addc_u32 s61, s61, s43
    s_add_u32 s60, s60, 0x4c957f2d
    s_addc_u32 s61, s61, 0x5851f42d
    v_mov_b64 v[40:41], s[60:61]
    v_mov_b64 v[44:45], s[60:61]
    s_bitcmp1_b32 s50, 0
    s_waitcnt vmcnt(0)
    s_cbranch_scc1 L_kv_v
    ds_read_b64_tr_b16 v[208:209], v6 offset:0
    ds_read_b64_tr_b16 v[210:211], v6 offset:128
    ds_read_b128 v[232:235], v11 offset:20992
    ds_read_b64_tr_b16 v[212:213], v6 offset:1024
    ds_read_b64_tr_b16 v[214:215], v6 offset:1152
    ds_read_b128 v[236:239], v11 offset:21056
    ds_read_b64_tr_b16 v[216:217], v6 offset:2048
    ds_read_b64_tr_b16 v[218:219], v6 offset:2176
    ds_read_b128 v[240:243], v11 offset:21120
    ds_read_b64_tr_b16 v[220:221], v6 offset:3072
    ds_read_b64_tr_b16 v[222:223], v6 offset:3200
    ds_read_b128 v[244:247], v11 offset:21184
    s_waitcnt lgkmcnt(10)
    v_mfma_f32_16x16x32_bf16 v[224:227], v[208:211], v[192:195], 0
    s_waitcnt lgkmcnt(9)
    v_mfma_f32_16x16x32_bf16 v[228:231], v[208:211], v[232:235], 0
    s_waitcnt lgkmcnt(7)
    v_mfma_f32_16x16x32_bf16 v[224:227], v[212:215], v[196:199], v[224:227]
    s_waitcnt lgkmcnt(6)
    v_mfma_f32_16x16x32_bf16 v[228:231], v[212:215], v[236:239], v[228:231]
    s_waitcnt lgkmcnt(4)
    v_mfma_f32_16x16x32_bf16 v[224:227], v[216:219], v[200:203], v[224:227]
    s_waitcnt lgkmcnt(3)
    v_mfma_f32_16x16x32_bf16 v[228:231], v[216:219], v[240:243], v[228:231]
    s_waitcnt lgkmcnt(1)
    v_mfma_f32_16x16x32_bf16 v[224:227], v[220:223], v[204:207], v[224:227]
    s_waitcnt lgkmcnt(0)
    v_mfma_f32_16x16x32_bf16 v[228:231], v[220:223], v[244:247], v[228:231]
    s_lshl_b32 s54, s53, 14
    s_mul_i32 s55, s52, 5120
    s_bitset1_b32 s54, 15
    v_add_u32 v13, s54, v5
    v_add_u32 v6, s55, v13
    s_nop 2
    v_pk_add_f32 v[224:225], v[224:225], v[228:229] neg_lo:[0,1] neg_hi:[0,1]
    v_pk_add_f32 v[226:227], v[226:227], v[230:231] neg_lo:[0,1] neg_hi:[0,1]
    s_branch L_kv_d
L_kv_v:
    ds_read_b64_tr_b16 v[208:209], v6 offset:0
    ds_read_b64_tr_b16 v[210:211], v6 offset:128
    ds_read_b64_tr_b16 v[212:213], v6 offset:1024
    ds_read_b64_tr_b16 v[214:215], v6 offset:1152
    ds_read_b64_tr_b16 v[216:217], v6 offset:2048
    ds_read_b64_tr_b16 v[218:219], v6 offset:2176
    ds_read_b64_tr_b16 v[220:221], v6 offset:3072
L_st1440:
    s_cbranch_execz L_t0r
    ds_read_b64_tr_b16 v[222:223], v6 offset:3200
    s_waitcnt lgkmcnt(6)
    v_mfma_f32_16x16x32_bf16 v[224:227], v[192:195], v[208:211], 0
    s_waitcnt lgkmcnt(4)
    v_mfma_f32_16x16x32_bf16 v[224:227], v[196:199], v[212:215], v[224:227]
    s_waitcnt lgkmcnt(2)
    v_mfma_f32_16x16x32_bf16 v[224:227], v[200:203], v[216:219], v[224:227]
    s_waitcnt lgkmcnt(0)
    v_mfma_f32_16x16x32_bf16 v[224:227], v[204:207], v[220:223], v[224:227]
    s_lshl_b32 s54, s53, 14
    s_mul_i32 s55, s52, 5120
    s_bitset1_b32 s54, 15
    v_add_u32 v13, s54, v5
    v_add_u32 v6, s55, v13
    s_nop 2
L_kv_d:
    ds_write_b128 v14, v[224:227]
    s_mov_b64 exec, 1
    ds_write_b64 v4, v[40:41] offset:32
    ds_add_rtn_u32 v14, v4, v25 offset:0
    s_mov_b64 exec, -1
    s_waitcnt lgkmcnt(0)
    v_readfirstlane_b32 s36, v14
    s_cmp_lg_u32 s36, 3
    s_cbranch_scc1 L_kv_j
    ds_read_b128 v[208:211], v15 offset:0
    ds_read_b128 v[212:215], v15 offset:1024
    ds_read_b128 v[216:219], v15 offset:2048
    ds_read_b128 v[220:223], v15 offset:3072
    s_waitcnt lgkmcnt(2)
    v_pk_add_f32 v[208:209], v[208:209], v[212:213]
    v_pk_add_f32 v[210:211], v[210:211], v[214:215]
    s_waitcnt lgkmcnt(0)
    v_pk_add_f32 v[216:217], v[216:217], v[220:221]
    v_pk_add_f32 v[218:219], v[218:219], v[222:223]
    v_pk_add_f32 v[208:209], v[208:209], v[216:217]
    v_pk_add_f32 v[210:211], v[210:211], v[218:219]
    v_pk_mul_f32 v[208:209], v[208:209], s[72:73]
    v_pk_mul_f32 v[210:211], v[210:211], s[72:73]
    v_cvt_pk_bf16_f32 v42, v208, v209
    v_cvt_pk_bf16_f32 v43, v210, v211
    s_mov_b32 exec_hi, 0
    buffer_store_dwordx4 v[40:43], v10, s[4:7], s34 offen
    s_not_b64 exec, exec
    buffer_store_dwordx4 v[42:45], v10, s[4:7], s34 offen
    s_mov_b64 exec, -1
    buffer_store_dwordx2 v[42:43], v7, s[4:7], s58 offen sc1
    buffer_store_dwordx2 v[42:43], v7, s[4:7], s65 offen sc1
L_kv_j:
    ds_write_b128 v8, v[192:195]
    ds_write_b128 v37, v[196:199]
    ds_write_b128 v38, v[200:203]
    ds_write_b128 v39, v[204:207]
    v_xor_b32 v7, 0x4000, v6
    s_lshl_b32 s54, s46, 11
    s_bitset1_b32 s54, 17
    v_add_u32 v10, s54, v5
    v_xor_b32 v11, 0x800, v10
    v_mov_b32 v9, 0xdddddddd
    v_mov_b64 v[128:129], 0
    v_mov_b64 v[130:131], 0
    v_mov_b64 v[132:133], 0
    v_mov_b64 v[134:135], 0
    v_mov_b64 v[136:137], 0
    v_mov_b64 v[138:139], 0
    v_mov_b64 v[140:141], 0
    v_mov_b64 v[142:143], 0
    v_mov_b64 v[144:145], 0
    v_mov_b64 v[146:147], 0
    v_mov_b64 v[148:149], 0
    v_mov_b64 v[150:151], 0
    v_mov_b64 v[152:153], 0
    v_mov_b64 v[154:155], 0
    v_mov_b64 v[156:157], 0
    v_mov_b64 v[158:159], 0
    v_mov_b64 v[160:161], 0
    v_mov_b64 v[162:163], 0
    v_mov_b64 v[164:165], 0
    v_mov_b64 v[166:167], 0
    v_mov_b64 v[168:169], 0
    v_mov_b64 v[170:171], 0
    v_mov_b64 v[172:173], 0
    v_mov_b64 v[174:175], 0
    v_mov_b64 v[176:177], 0
    v_mov_b64 v[178:179], 0
    v_mov_b64 v[180:181], 0
    v_mov_b64 v[182:183], 0
    v_mov_b64 v[184:185], 0
    v_mov_b64 v[186:187], 0
    v_mov_b64 v[188:189], 0
    v_mov_b64 v[190:191], 0
    s_mov_b64 exec, 0
    s_cmp_eq_u32 s46, 0
    s_cbranch_scc1 L_st1c40
    s_cmp_eq_u32 s46, 1
    s_cbranch_scc1 L_stmid_0
L_tbr:
    s_mov_b64 exec, -1
    s_waitcnt lgkmcnt(0)
    s_barrier
    ds_read_b128 v[192:195], v48 offset:0
    ds_read_b64_tr_b16 v[196:197], v26 offset:16384
    ds_read_b64_tr_b16 v[198:199], v26 offset:16896
    ds_read_b128 v[200:203], v49 offset:0
    ds_read_b64_tr_b16 v[204:205], v26 offset:18432
    ds_read_b64_tr_b16 v[206:207], v26 offset:18944
    ds_read_b128 v[208:211], v50 offset:0
    ds_read_b64_tr_b16 v[212:213], v26 offset:20480
    ds_read_b64_tr_b16 v[214:215], v26 offset:20992
    ds_read_b128 v[216:219], v51 offset:0
    ds_read_b64_tr_b16 v[220:221], v26 offset:22528
    ds_read_b64_tr_b16 v[222:223], v26 offset:23040
    s_waitcnt lgkmcnt(9)
    v_mfma_f32_32x32x16_bf16 v[64:79], v[196:199], v[192:195], 0
    ds_read_b128 v[224:227], v52 offset:0
    ds_read_b64_tr_b16 v[228:229], v26 offset:24576
    ds_read_b64_tr_b16 v[230:231], v26 offset:25088
    s_waitcnt lgkmcnt(9)
    v_mfma_f32_32x32x16_bf16 v[64:79], v[204:207], v[200:203], v[64:79]
    ds_read_b128 v[232:235], v53 offset:0
    ds_read_b64_tr_b16 v[236:237], v26 offset:26624
    ds_read_b64_tr_b16 v[238:239], v26 offset:27136
    s_waitcnt lgkmcnt(9)
    v_mfma_f32_32x32x16_bf16 v[64:79], v[212:215], v[208:211], v[64:79]
    ds_read_b128 v[240:243], v54 offset:0
    ds_read_b64_tr_b16 v[244:245], v26 offset:28672
    ds_read_b64_tr_b16 v[246:247], v26 offset:29184
    s_waitcnt lgkmcnt(9)
    v_mfma_f32_32x32x16_bf16 v[64:79], v[220:223], v[216:219], v[64:79]
    ds_read_b128 v[248:251], v55 offset:0
    ds_read_b64_tr_b16 v[252:253], v26 offset:30720
    ds_read_b64_tr_b16 v[254:255], v26 offset:31232
    s_cmp_lg_u32 s36, 3
    s_cbranch_scc1 L_fp_1
    s_waitcnt vmcnt(0)
    s_mov_b64 exec, 1
    buffer_store_dwordx2 v[40:41], v1, s[4:7], s75 offen sc1
    s_mov_b64 exec, -1
L_fp_1:
    s_barrier
    s_waitcnt lgkmcnt(9)
    v_mfma_f32_32x32x16_bf16 v[64:79], v[228:231], v[224:227], v[64:79]
    ds_read_b128 v[192:195], v48 offset:32768
    ds_read_b64_tr_b16 v[196:197], v26 offset:49152
    ds_read_b64_tr_b16 v[198:199], v26 offset:49664
    s_waitcnt lgkmcnt(9)
    v_mfma_f32_32x32x16_bf16 v[64:79], v[236:239], v[232:235], v[64:79]
    ds_read_b128 v[200:203], v49 offset:32768
    ds_read_b64_tr_b16 v[204:205], v26 offset:51200
    ds_read_b64_tr_b16 v[206:207], v26 offset:51712
    s_waitcnt lgkmcnt(9)
    v_mfma_f32_32x32x16_bf16 v[64:79], v[244:247], v[240:243], v[64:79]
    ds_read_b128 v[208:211], v50 offset:32768
    ds_read_b64_tr_b16 v[212:213], v26 offset:53248
    ds_read_b64_tr_b16 v[214:215], v26 offset:53760
    s_waitcnt lgkmcnt(9)
    v_mfma_f32_32x32x16_bf16 v[64:79], v[252:255], v[248:251], v[64:79]
    ds_read_b128 v[216:219], v51 offset:32768
    ds_read_b64_tr_b16 v[220:221], v26 offset:55296
    ds_read_b64_tr_b16 v[222:223], v26 offset:55808
    s_waitcnt lgkmcnt(9)
    v_mfma_f32_32x32x16_bf16 v[64:79], v[196:199], v[192:195], v[64:79]
    ds_read_b128 v[224:227], v52 offset:32768
    ds_read_b64_tr_b16 v[228:229], v26 offset:57344
    ds_read_b64_tr_b16 v[230:231], v26 offset:57856
    s_waitcnt lgkmcnt(9)
    v_mfma_f32_32x32x16_bf16 v[64:79], v[204:207], v[200:203], v[64:79]
    ds_read_b128 v[232:235], v53 offset:32768
    ds_read_b64_tr_b16 v[236:237], v26 offset:59392
    ds_read_b64_tr_b16 v[238:239], v26 offset:59904
    s_waitcnt lgkmcnt(9)
L_st1840:
    s_cbranch_execz L_tar
    v_mfma_f32_32x32x16_bf16 v[64:79], v[212:215], v[208:211], v[64:79]
    ds_read_b128 v[240:243], v54 offset:32768
    ds_read_b64_tr_b16 v[244:245], v26 offset:61440
    ds_read_b64_tr_b16 v[246:247], v26 offset:61952
    s_waitcnt lgkmcnt(9)
    v_mfma_f32_32x32x16_bf16 v[64:79], v[220:223], v[216:219], v[64:79]
    ds_read_b128 v[248:251], v55 offset:32768
    ds_read_b64_tr_b16 v[252:253], v26 offset:63488
    ds_read_b64_tr_b16 v[254:255], v26 offset:64000
    s_barrier
    s_waitcnt lgkmcnt(9)
    v_mfma_f32_32x32x16_bf16 v[64:79], v[228:231], v[224:227], v[64:79]
    ds_read_b128 v[192:195], v56 offset:0
    ds_read_b64_tr_b16 v[196:197], v27 offset:16384
    ds_read_b64_tr_b16 v[198:199], v27 offset:16896
    s_waitcnt lgkmcnt(9)
    v_mfma_f32_32x32x16_bf16 v[64:79], v[236:239], v[232:235], v[64:79]
    ds_read_b128 v[200:203], v57 offset:0
    ds_read_b64_tr_b16 v[204:205], v27 offset:18432
    ds_read_b64_tr_b16 v[206:207], v27 offset:18944
    s_waitcnt lgkmcnt(9)
    v_mfma_f32_32x32x16_bf16 v[64:79], v[244:247], v[240:243], v[64:79]
    ds_read_b128 v[208:211], v58 offset:0
    ds_read_b64_tr_b16 v[212:213], v27 offset:20480
    ds_read_b64_tr_b16 v[214:215], v27 offset:20992
    s_waitcnt lgkmcnt(9)
    v_mfma_f32_32x32x16_bf16 v[64:79], v[252:255], v[248:251], v[64:79]
    ds_read_b128 v[216:219], v59 offset:0
    ds_read_b64_tr_b16 v[220:221], v27 offset:22528
    ds_read_b64_tr_b16 v[222:223], v27 offset:23040
    s_waitcnt lgkmcnt(9)
    v_mfma_f32_32x32x16_bf16 v[64:79], v[196:199], v[192:195], v[64:79]
    ds_read_b128 v[224:227], v60 offset:0
    ds_read_b64_tr_b16 v[228:229], v27 offset:24576
    ds_read_b64_tr_b16 v[230:231], v27 offset:25088
    s_waitcnt lgkmcnt(9)
    v_mfma_f32_32x32x16_bf16 v[64:79], v[204:207], v[200:203], v[64:79]
    ds_read_b128 v[232:235], v61 offset:0
    ds_read_b64_tr_b16 v[236:237], v27 offset:26624
    ds_read_b64_tr_b16 v[238:239], v27 offset:27136
    s_waitcnt lgkmcnt(9)
    v_mfma_f32_32x32x16_bf16 v[64:79], v[212:215], v[208:211], v[64:79]
    ds_read_b128 v[240:243], v62 offset:0
    ds_read_b64_tr_b16 v[244:245], v27 offset:28672
    ds_read_b64_tr_b16 v[246:247], v27 offset:29184
    s_waitcnt lgkmcnt(9)
    v_mfma_f32_32x32x16_bf16 v[64:79], v[220:223], v[216:219], v[64:79]
    ds_read_b128 v[248:251], v63 offset:0
    ds_read_b64_tr_b16 v[252:253], v27 offset:30720
    ds_read_b64_tr_b16 v[254:255], v27 offset:31232
    s_barrier
    s_waitcnt lgkmcnt(9)
    v_mfma_f32_32x32x16_bf16 v[64:79], v[228:231], v[224:227], v[64:79]
    ds_read_b128 v[192:195], v56 offset:32768
    ds_read_b64_tr_b16 v[196:197], v27 offset:49152
    ds_read_b64_tr_b16 v[198:199], v27 offset:49664
    s_waitcnt lgkmcnt(9)
    v_mfma_f32_32x32x16_bf16 v[64:79], v[236:239], v[232:235], v[64:79]
    ds_read_b128 v[200:203], v57 offset:32768
    ds_read_b64_tr_b16 v[204:205], v27 offset:51200
    ds_read_b64_tr_b16 v[206:207], v27 offset:51712
    s_waitcnt lgkmcnt(9)
    v_mfma_f32_32x32x16_bf16 v[64:79], v[244:247], v[240:243], v[64:79]
    ds_read_b128 v[208:211], v58 offset:32768
    ds_read_b64_tr_b16 v[212:213], v27 offset:53248
    ds_read_b64_tr_b16 v[214:215], v27 offset:53760
    s_waitcnt lgkmcnt(9)
    v_mfma_f32_32x32x16_bf16 v[64:79], v[252:255], v[248:251], v[64:79]
    ds_read_b128 v[216:219], v59 offset:32768
    ds_read_b64_tr_b16 v[220:221], v27 offset:55296
    ds_read_b64_tr_b16 v[222:223], v27 offset:55808
    s_waitcnt lgkmcnt(9)
    v_mfma_f32_32x32x16_bf16 v[64:79], v[196:199], v[192:195], v[64:79]
    ds_read_b128 v[224:227], v60 offset:32768
    ds_read_b64_tr_b16 v[228:229], v27 offset:57344
    ds_read_b64_tr_b16 v[230:231], v27 offset:57856
    s_waitcnt lgkmcnt(9)
    v_mfma_f32_32x32x16_bf16 v[64:79], v[204:207], v[200:203], v[64:79]
    ds_read_b128 v[232:235], v61 offset:32768
    ds_read_b64_tr_b16 v[236:237], v27 offset:59392
    ds_read_b64_tr_b16 v[238:239], v27 offset:59904
    s_waitcnt lgkmcnt(9)
    v_mfma_f32_32x32x16_bf16 v[64:79], v[212:215], v[208:211], v[64:79]
    ds_read_b128 v[240:243], v62 offset:32768
    ds_read_b64_tr_b16 v[244:245], v27 offset:61440
    ds_read_b64_tr_b16 v[246:247], v27 offset:61952
    s_waitcnt lgkmcnt(9)
    v_mfma_f32_32x32x16_bf16 v[64:79], v[220:223], v[216:219], v[64:79]
    ds_read_b128 v[248:251], v63 offset:32768
    ds_read_b64_tr_b16 v[252:253], v27 offset:63488
    ds_read_b64_tr_b16 v[254:255], v27 offset:64000
    v_mov_b64 v[202:203], v[90:91]
    v_mov_b64 v[204:205], v[90:91]
    v_mov_b64 v[210:211], v[90:91]
    v_mov_b64 v[212:213], v[90:91]
    s_waitcnt lgkmcnt(9)
    v_mfma_f32_32x32x16_bf16 v[64:79], v[228:231], v[224:227], v[64:79]
    s_waitcnt lgkmcnt(6)
    v_mfma_f32_32x32x16_bf16 v[64:79], v[236:239], v[232:235], v[64:79]
    s_waitcnt lgkmcnt(3)
    v_mfma_f32_32x32x16_bf16 v[64:79], v[244:247], v[240:243], v[64:79]
    v_mov_b64 v[226:227], v[90:91]
    v_mov_b64 v[228:229], v[90:91]
    v_mov_b64 v[234:235], v[90:91]
    v_mov_b64 v[236:237], v[90:91]
    s_waitcnt lgkmcnt(0)
    v_mfma_f32_32x32x16_bf16 v[64:79], v[252:255], v[248:251], v[64:79]
    s_nop 11
    v_cvt_pk_bf16_f32 v16, v64, v65
    v_cvt_pk_bf16_f32 v17, v66, v67
    v_cvt_pk_bf16_f32 v18, v68, v69
    v_cvt_pk_bf16_f32 v19, v70, v71
    ds_write_b128 v10, v[16:19] offset:20992
    v_cvt_pk_bf16_f32 v20, v72, v73
    v_cvt_pk_bf16_f32 v21, v74, v75
    v_cvt_pk_bf16_f32 v22, v76, v77
    v_cvt_pk_bf16_f32 v23, v78, v79
    ds_write_b128 v10, v[20:23] offset:22016
    s_waitcnt lgkmcnt(0)
    s_barrier
    ds_read_b128 v[82:85], v13 offset:0
    ds_read_b32 v14, v4 offset:8
    s_waitcnt lgkmcnt(1)
    v_mfma_f32_32x32x16_bf16 v[48:63], v[82:85], v[16:19], 0
    s_mov_b64 exec, s[28:29]
    ds_read_b128 v[90:93], v13 offset:1024
    ds_read_b128 v[98:101], v13 offset:1280
    ds_read_b128 v[114:117], v13 offset:3072
    ds_read_b128 v[122:125], v13 offset:3328
    s_mov_b64 exec, -1
    ds_read_b128 v[106:109], v13 offset:2048
    ds_read_b128 v[24:27], v11 offset:20992
    ds_read_b128 v[28:31], v11 offset:22016
    s_waitcnt lgkmcnt(7)
    v_cmp_ne_u32 vcc, 0, v14
    s_nop 0
    s_cbranch_vccnz L_r0
L_c0:
    v_exp_f32 v48, v48
    v_exp_f32 v49, v49
    v_exp_f32 v50, v50
    v_exp_f32 v51, v51
    v_exp_f32 v52, v52
    v_mfma_f32_32x32x16_bf16 v[64:79], v[82:85], v[20:23], 0
    v_exp_f32 v53, v53
    v_exp_f32 v54, v54
    v_exp_f32 v55, v55
    v_exp_f32 v56, v56
    s_waitcnt lgkmcnt(0)
    v_exp_f32 v57, v57
    v_exp_f32 v58, v58
    v_exp_f32 v59, v59
    v_smfmac_f32_32x32x32_bf16 v[128:143], v[90:93], v[48:55], v9
    v_exp_f32 v60, v60
    v_exp_f32 v61, v61
    v_exp_f32 v62, v62
    v_exp_f32 v63, v63
    v_exp_f32 v64, v64
    v_exp_f32 v65, v65
    v_smfmac_f32_32x32x32_bf16 v[128:143], v[98:101], v[56:63], v9
L_st1c40:
    s_cbranch_execz L_tbr
    v_exp_f32 v66, v66
    v_exp_f32 v67, v67
    v_exp_f32 v68, v68
    v_mfma_f32_32x32x16_bf16 v[48:63], v[82:85], v[24:27], 0
    v_exp_f32 v69, v69
    v_exp_f32 v70, v70
    v_exp_f32 v71, v71
    v_exp_f32 v72, v72
    v_exp_f32 v73, v73
    v_exp_f32 v74, v74
    v_exp_f32 v75, v75
    v_smfmac_f32_32x32x32_bf16 v[144:159], v[90:93], v[64:71], v9
    v_exp_f32 v76, v76
    v_exp_f32 v77, v77
    v_exp_f32 v78, v78
    v_exp_f32 v79, v79
    v_exp_f32 v48, v48
    v_exp_f32 v49, v49
    v_smfmac_f32_32x32x32_bf16 v[144:159], v[98:101], v[72:79], v9
    v_exp_f32 v50, v50
    v_exp_f32 v51, v51
    v_exp_f32 v52, v52
    v_mfma_f32_32x32x16_bf16 v[64:79], v[82:85], v[28:31], 0
    v_exp_f32 v53, v53
    v_exp_f32 v54, v54
    v_exp_f32 v55, v55
    v_exp_f32 v56, v56
    v_exp_f32 v57, v57
    v_exp_f32 v58, v58
    v_exp_f32 v59, v59
    v_smfmac_f32_32x32x32_bf16 v[160:175], v[90:93], v[48:55], v9
    v_exp_f32 v60, v60
    v_exp_f32 v61, v61
    v_exp_f32 v62, v62
    v_exp_f32 v63, v63
    v_exp_f32 v64, v64
    v_exp_f32 v65, v65
    v_smfmac_f32_32x32x32_bf16 v[160:175], v[98:101], v[56:63], v9
    v_exp_f32 v66, v66
    v_exp_f32 v67, v67
    v_exp_f32 v68, v68
    v_mfma_f32_32x32x16_bf16 v[48:63], v[106:109], v[16:19], 0
    v_exp_f32 v69, v69
    v_exp_f32 v70, v70
    v_exp_f32 v71, v71
    v_exp_f32 v72, v72
    v_exp_f32 v73, v73
    v_exp_f32 v74, v74
    v_exp_f32 v75, v75
    v_smfmac_f32_32x32x32_bf16 v[176:191], v[90:93], v[64:71], v9
    v_exp_f32 v76, v76
    v_exp_f32 v77, v77
    v_exp_f32 v78, v78
    v_exp_f32 v79, v79
    v_exp_f32 v48, v48
    v_exp_f32 v49, v49
    v_smfmac_f32_32x32x32_bf16 v[176:191], v[98:101], v[72:79], v9
    v_exp_f32 v50, v50
    v_exp_f32 v51, v51
    v_exp_f32 v52, v52
    v_mfma_f32_32x32x16_bf16 v[64:79], v[106:109], v[20:23], 0
    v_exp_f32 v53, v53
    v_exp_f32 v54, v54
    v_exp_f32 v55, v55
    v_exp_f32 v56, v56
    v_exp_f32 v57, v57
    v_exp_f32 v58, v58
    v_exp_f32 v59, v59
    v_smfmac_f32_32x32x32_bf16 v[128:143], v[114:117], v[48:55], v9
    v_exp_f32 v60, v60
    v_exp_f32 v61, v61
    v_exp_f32 v62, v62
    v_exp_f32 v63, v63
    v_exp_f32 v64, v64
    v_exp_f32 v65, v65
    v_smfmac_f32_32x32x32_bf16 v[128:143], v[122:125], v[56:63], v9
    v_exp_f32 v66, v66
    v_exp_f32 v67, v67
    v_exp_f32 v68, v68
    v_mfma_f32_32x32x16_bf16 v[48:63], v[106:109], v[24:27], 0
    ds_read_u8 v14, v4 offset:16
    ds_read_b128 v[194:197], v13 offset:4096
    ds_read_b128 v[218:221], v13 offset:6144
    v_exp_f32 v69, v69
    v_exp_f32 v70, v70
    v_exp_f32 v71, v71
    v_exp_f32 v72, v72
    v_exp_f32 v73, v73
    v_exp_f32 v74, v74
    v_exp_f32 v75, v75
    v_smfmac_f32_32x32x32_bf16 v[144:159], v[114:117], v[64:71], v9
    s_mov_b64 exec, s[28:29]
    ds_read_b128 v[202:205], v13 offset:5120
    ds_read_b128 v[210:213], v13 offset:5376
    ds_read_b128 v[226:229], v13 offset:7168
    ds_read_b128 v[234:237], v13 offset:7424
    s_mov_b64 exec, -1
    v_exp_f32 v76, v76
    v_exp_f32 v77, v77
    v_exp_f32 v78, v78
    v_exp_f32 v79, v79
    v_exp_f32 v48, v48
    v_exp_f32 v49, v49
    v_smfmac_f32_32x32x32_bf16 v[144:159], v[122:125], v[72:79], v9
    s_waitcnt lgkmcnt(0)
    v_cmp_ne_u32 vcc, 4, v14
    v_exp_f32 v50, v50
    v_exp_f32 v51, v51
    v_exp_f32 v52, v52
    s_cbranch_vccnz L_l2r
L_l2d:
    v_mfma_f32_32x32x16_bf16 v[64:79], v[106:109], v[28:31], 0
    buffer_load_dwordx4 v[82:85], v3, s[4:7], s63 offen offset:0
    v_exp_f32 v53, v53
    v_exp_f32 v54, v54
    v_exp_f32 v55, v55
    v_exp_f32 v56, v56
    v_exp_f32 v57, v57
    v_exp_f32 v58, v58
    v_exp_f32 v59, v59
    v_smfmac_f32_32x32x32_bf16 v[160:175], v[114:117], v[48:55], v9
    s_mov_b64 exec, s[28:29]
    buffer_load_dwordx4 v[90:93], v2, s[4:7], s63 offen offset:0
    buffer_load_dwordx4 v[98:101], v2, s[4:7], s63 offen offset:256
    s_mov_b64 exec, -1
    v_exp_f32 v60, v60
    v_exp_f32 v61, v61
    v_exp_f32 v62, v62
    v_exp_f32 v63, v63
    v_exp_f32 v64, v64
    v_exp_f32 v65, v65
    v_smfmac_f32_32x32x32_bf16 v[160:175], v[122:125], v[56:63], v9
    ds_read_u8 v12, v4 offset:17
    v_exp_f32 v66, v66
    v_exp_f32 v67, v67
    v_exp_f32 v68, v68
    v_mfma_f32_32x32x16_bf16 v[48:63], v[194:197], v[16:19], 0
    buffer_load_dwordx4 v[106:109], v3, s[4:7], s63 offen offset:1024
    v_exp_f32 v69, v69
    v_exp_f32 v70, v70
    v_exp_f32 v71, v71
    v_exp_f32 v72, v72
    v_exp_f32 v73, v73
    v_exp_f32 v74, v74
    v_exp_f32 v75, v75
    v_smfmac_f32_32x32x32_bf16 v[176:191], v[114:117], v[64:71], v9
    s_waitcnt lgkmcnt(0)
    v_cmp_ne_u32 vcc, 4, v12
    v_exp_f32 v76, v76
    v_exp_f32 v77, v77
    v_exp_f32 v78, v78
    v_exp_f32 v79, v79
    s_cmp_eq_u32 s77, s77
    s_branch L_mid
L_l2r:
    ds_read_u8 v14, v4 offset:16
    ds_read_b128 v[194:197], v13 offset:4096
    ds_read_b128 v[218:221], v13 offset:6144
    s_mov_b64 exec, s[28:29]
    ds_read_b128 v[202:205], v13 offset:5120
    ds_read_b128 v[210:213], v13 offset:5376
    ds_read_b128 v[226:229], v13 offset:7168
    ds_read_b128 v[234:237], v13 offset:7424
    s_mov_b64 exec, -1
    s_waitcnt lgkmcnt(0)
    v_readfirstlane_b32 s59, v14
    s_cmp_eq_u32 s59, 4
    s_cbranch_scc1 L_l2d
    s_bitcmp1_b32 s59, 2
    s_cbranch_scc0 L_l2r
    s_branch L_l2x
L_f2r:
    ds_read_u8 v12, v4 offset:17
    s_waitcnt lgkmcnt(0)
    v_cmp_ne_u32 vcc, 4, v12
    s_cbranch_vccnz L_f2r
    s_branch L_f2b
    .p2align 6
    s_nop 0
    .p2align 6
L_st2000:
    s_cbranch_execz L_tyr
    s_nop 0
    .p2align 6
L_loop:
    v_exp_f32 v76, v76
    v_exp_f32 v77, v77
    v_exp_f32 v78, v78
    v_exp_f32 v79, v79
    v_exp_f32 v48, v48
    v_exp_f32 v49, v49
    v_smfmac_f32_32x32x32_bf16 v[144:159], v[234:237], v[72:79], v9
    v_exp_f32 v50, v50
    v_exp_f32 v51, v51
    v_exp_f32 v52, v52
    v_mfma_f32_32x32x16_bf16 v[64:79], v[218:221], v[28:31], 0
    v_exp_f32 v53, v53
    v_exp_f32 v54, v54
    v_exp_f32 v55, v55
    v_exp_f32 v56, v56
    v_exp_f32 v57, v57
    v_exp_f32 v58, v58
    v_exp_f32 v59, v59
    v_smfmac_f32_32x32x32_bf16 v[160:175], v[226:229], v[48:55], v9
    v_exp_f32 v60, v60
    v_exp_f32 v61, v61
    v_exp_f32 v62, v62
    v_exp_f32 v63, v63
    v_exp_f32 v64, v64
    v_exp_f32 v65, v65
    v_smfmac_f32_32x32x32_bf16 v[160:175], v[234:237], v[56:63], v9
    s_waitcnt vmcnt(6)
    v_exp_f32 v66, v66
    v_exp_f32 v67, v67
    v_exp_f32 v68, v68
    v_mfma_f32_32x32x16_bf16 v[48:63], v[82:85], v[16:19], 0
    buffer_load_dwordx4 v[218:221], v3, s[4:7], s63 offen offset:3072
    v_exp_f32 v69, v69
    v_exp_f32 v70, v70
    v_exp_f32 v71, v71
    v_exp_f32 v72, v72
    v_exp_f32 v73, v73
    v_exp_f32 v74, v74
    v_exp_f32 v75, v75
    v_smfmac_f32_32x32x32_bf16 v[176:191], v[226:229], v[64:71], v9
    v_exp_f32 v76, v76
    v_exp_f32 v77, v77
    v_exp_f32 v78, v78
    v_exp_f32 v79, v79
    v_exp_f32 v48, v48
    v_exp_f32 v49, v49
    v_smfmac_f32_32x32x32_bf16 v[176:191], v[234:237], v[72:79], v9
    v_exp_f32 v50, v50
    v_exp_f32 v51, v51
    v_exp_f32 v52, v52
    v_mfma_f32_32x32x16_bf16 v[64:79], v[82:85], v[20:23], 0
    v_exp_f32 v53, v53
    v_exp_f32 v54, v54
    v_exp_f32 v55, v55
    v_exp_f32 v56, v56
    v_exp_f32 v57, v57
    v_exp_f32 v58, v58
    v_exp_f32 v59, v59
    v_smfmac_f32_32x32x32_bf16 v[128:143], v[90:93], v[48:55], v9
    v_exp_f32 v60, v60
    v_exp_f32 v61, v61
    v_exp_f32 v62, v62
    v_exp_f32 v63, v63
    v_exp_f32 v64, v64
    v_exp_f32 v65, v65
    v_smfmac_f32_32x32x32_bf16 v[128:143], v[98:101], v[56:63], v9
    s_mov_b64 exec, s[28:29]
    buffer_load_dwordx4 v[226:229], v2, s[4:7], s63 offen offset:3072
    buffer_load_dwordx4 v[234:237], v2, s[4:7], s63 offen offset:3328
    s_mov_b64 exec, -1
    v_exp_f32 v66, v66
    v_exp_f32 v67, v67
    v_exp_f32 v68, v68
    v_mfma_f32_32x32x16_bf16 v[48:63], v[82:85], v[24:27], 0
    v_exp_f32 v69, v69
    v_exp_f32 v70, v70
    v_exp_f32 v71, v71
    v_exp_f32 v72, v72
    v_exp_f32 v73, v73
    v_exp_f32 v74, v74
    v_exp_f32 v75, v75
    v_smfmac_f32_32x32x32_bf16 v[144:159], v[90:93], v[64:71], v9
    v_exp_f32 v76, v76
    v_exp_f32 v77, v77
    v_exp_f32 v78, v78
    v_exp_f32 v79, v79
    v_exp_f32 v48, v48
    v_exp_f32 v49, v49
    v_smfmac_f32_32x32x32_bf16 v[144:159], v[98:101], v[72:79], v9
    s_absdiff_i32 s63, s63, s77
    s_cbranch_vccnz L_f2r
L_f2b:
    v_exp_f32 v50, v50
    v_exp_f32 v51, v51
    v_exp_f32 v52, v52
    v_mfma_f32_32x32x16_bf16 v[64:79], v[82:85], v[28:31], 0
    v_exp_f32 v53, v53
    v_exp_f32 v54, v54
    v_exp_f32 v55, v55
    v_exp_f32 v56, v56
    v_exp_f32 v57, v57
    v_exp_f32 v58, v58
    v_exp_f32 v59, v59
    v_smfmac_f32_32x32x32_bf16 v[160:175], v[90:93], v[48:55], v9
    v_exp_f32 v60, v60
    v_exp_f32 v61, v61
    v_exp_f32 v62, v62
    v_exp_f32 v63, v63
    v_exp_f32 v64, v64
    v_exp_f32 v65, v65
    v_smfmac_f32_32x32x32_bf16 v[160:175], v[98:101], v[56:63], v9
    s_waitcnt vmcnt(6)
    v_exp_f32 v66, v66
    v_exp_f32 v67, v67
    v_exp_f32 v68, v68
    v_mfma_f32_32x32x16_bf16 v[48:63], v[106:109], v[16:19], 0
    buffer_load_dwordx4 v[82:85], v3, s[4:7], s63 offen offset:0
    v_exp_f32 v69, v69
    v_exp_f32 v70, v70
    v_exp_f32 v71, v71
    v_exp_f32 v72, v72
    v_exp_f32 v73, v73
    v_exp_f32 v74, v74
    v_exp_f32 v75, v75
    v_smfmac_f32_32x32x32_bf16 v[176:191], v[90:93], v[64:71], v9
    v_exp_f32 v76, v76
    v_exp_f32 v77, v77
    v_exp_f32 v78, v78
    v_exp_f32 v79, v79
    v_exp_f32 v48, v48
    v_exp_f32 v49, v49
    v_smfmac_f32_32x32x32_bf16 v[176:191], v[98:101], v[72:79], v9
    v_exp_f32 v50, v50
    v_exp_f32 v51, v51
    v_exp_f32 v52, v52
    v_mfma_f32_32x32x16_bf16 v[64:79], v[106:109], v[20:23], 0
    v_exp_f32 v53, v53
    v_exp_f32 v54, v54
    v_exp_f32 v55, v55
    v_exp_f32 v56, v56
    v_exp_f32 v57, v57
    v_exp_f32 v58, v58
    v_exp_f32 v59, v59
    v_smfmac_f32_32x32x32_bf16 v[128:143], v[114:117], v[48:55], v9
    v_exp_f32 v60, v60
    v_exp_f32 v61, v61
    v_exp_f32 v62, v62
    v_exp_f32 v63, v63
    v_exp_f32 v64, v64
    v_exp_f32 v65, v65
    v_smfmac_f32_32x32x32_bf16 v[128:143], v[122:125], v[56:63], v9
    s_mov_b64 exec, s[28:29]
    buffer_load_dwordx4 v[90:93], v2, s[4:7], s63 offen offset:0
    buffer_load_dwordx4 v[98:101], v2, s[4:7], s63 offen offset:256
    s_mov_b64 exec, -1
    v_exp_f32 v66, v66
    v_exp_f32 v67, v67
    v_exp_f32 v68, v68
    v_mfma_f32_32x32x16_bf16 v[48:63], v[106:109], v[24:27], 0
    v_exp_f32 v69, v69
    v_exp_f32 v70, v70
    v_exp_f32 v71, v71
    v_exp_f32 v72, v72
    v_exp_f32 v73, v73
    v_exp_f32 v74, v74
    v_exp_f32 v75, v75
    v_smfmac_f32_32x32x32_bf16 v[144:159], v[114:117], v[64:71], v9
    v_exp_f32 v76, v76
    v_exp_f32 v77, v77
    v_exp_f32 v78, v78
    v_exp_f32 v79, v79
    v_exp_f32 v48, v48
    v_exp_f32 v49, v49
    v_smfmac_f32_32x32x32_bf16 v[144:159], v[122:125], v[72:79], v9
    v_exp_f32 v50, v50
    v_exp_f32 v51, v51
    v_exp_f32 v52, v52
    v_mfma_f32_32x32x16_bf16 v[64:79], v[106:109], v[28:31], 0
    v_exp_f32 v53, v53
    v_exp_f32 v54, v54
    v_exp_f32 v55, v55
    v_exp_f32 v56, v56
    v_exp_f32 v57, v57
    v_exp_f32 v58, v58
    v_exp_f32 v59, v59
    v_smfmac_f32_32x32x32_bf16 v[160:175], v[114:117], v[48:55], v9
    v_exp_f32 v60, v60
    v_exp_f32 v61, v61
    v_exp_f32 v62, v62
    v_exp_f32 v63, v63
    v_exp_f32 v64, v64
    v_exp_f32 v65, v65
    v_smfmac_f32_32x32x32_bf16 v[160:175], v[122:125], v[56:63], v9
    s_waitcnt vmcnt(6)
    v_exp_f32 v66, v66
    v_exp_f32 v67, v67
    v_exp_f32 v68, v68
    v_mfma_f32_32x32x16_bf16 v[48:63], v[194:197], v[16:19], 0
    buffer_load_dwordx4 v[106:109], v3, s[4:7], s63 offen offset:1024
    v_exp_f32 v69, v69
    v_exp_f32 v70, v70
    v_exp_f32 v71, v71
    v_exp_f32 v72, v72
    v_exp_f32 v73, v73
    v_exp_f32 v74, v74
    v_exp_f32 v75, v75
    v_smfmac_f32_32x32x32_bf16 v[176:191], v[114:117], v[64:71], v9
L_stmid_0:
    s_cbranch_execz L_tbr
    v_exp_f32 v76, v76
    v_exp_f32 v77, v77
    v_exp_f32 v78, v78
    v_exp_f32 v79, v79
L_mid:
    v_exp_f32 v48, v48
    v_exp_f32 v49, v49
    v_smfmac_f32_32x32x32_bf16 v[176:191], v[122:125], v[72:79], v9
    v_exp_f32 v50, v50
    v_exp_f32 v51, v51
    v_exp_f32 v52, v52
    v_mfma_f32_32x32x16_bf16 v[64:79], v[194:197], v[20:23], 0
    v_exp_f32 v53, v53
    v_exp_f32 v54, v54
    v_exp_f32 v55, v55
    v_exp_f32 v56, v56
    v_exp_f32 v57, v57
    v_exp_f32 v58, v58
    v_exp_f32 v59, v59
    v_smfmac_f32_32x32x32_bf16 v[128:143], v[202:205], v[48:55], v9
    v_exp_f32 v60, v60
    v_exp_f32 v61, v61
    v_exp_f32 v62, v62
    v_exp_f32 v63, v63
    v_exp_f32 v64, v64
    v_exp_f32 v65, v65
    v_smfmac_f32_32x32x32_bf16 v[128:143], v[210:213], v[56:63], v9
    s_mov_b64 exec, s[28:29]
    buffer_load_dwordx4 v[114:117], v2, s[4:7], s63 offen offset:1024
    buffer_load_dwordx4 v[122:125], v2, s[4:7], s63 offen offset:1280
    s_mov_b64 exec, -1
    v_exp_f32 v66, v66
    v_exp_f32 v67, v67
    v_exp_f32 v68, v68
    v_mfma_f32_32x32x16_bf16 v[48:63], v[194:197], v[24:27], 0
    v_exp_f32 v69, v69
    v_exp_f32 v70, v70
    v_exp_f32 v71, v71
    v_exp_f32 v72, v72
    v_exp_f32 v73, v73
    v_exp_f32 v74, v74
    v_exp_f32 v75, v75
    v_smfmac_f32_32x32x32_bf16 v[144:159], v[202:205], v[64:71], v9
    v_exp_f32 v76, v76
    v_exp_f32 v77, v77
    v_exp_f32 v78, v78
    v_exp_f32 v79, v79
    v_exp_f32 v48, v48
    v_exp_f32 v49, v49
    v_smfmac_f32_32x32x32_bf16 v[144:159], v[210:213], v[72:79], v9
    v_exp_f32 v50, v50
    v_exp_f32 v51, v51
    v_exp_f32 v52, v52
    v_mfma_f32_32x32x16_bf16 v[64:79], v[194:197], v[28:31], 0
    v_exp_f32 v53, v53
    v_exp_f32 v54, v54
    v_exp_f32 v55, v55
    v_exp_f32 v56, v56
    v_exp_f32 v57, v57
    v_exp_f32 v58, v58
    v_exp_f32 v59, v59
    v_smfmac_f32_32x32x32_bf16 v[160:175], v[202:205], v[48:55], v9
    v_exp_f32 v60, v60
    v_exp_f32 v61, v61
    v_exp_f32 v62, v62
    v_exp_f32 v63, v63
    v_exp_f32 v64, v64
    v_exp_f32 v65, v65
    v_smfmac_f32_32x32x32_bf16 v[160:175], v[210:213], v[56:63], v9
    s_waitcnt vmcnt(6)
    v_exp_f32 v66, v66
    v_exp_f32 v67, v67
    v_exp_f32 v68, v68
    v_mfma_f32_32x32x16_bf16 v[48:63], v[218:221], v[16:19], 0
    buffer_load_dwordx4 v[194:197], v3, s[4:7], s63 offen offset:2048
    v_exp_f32 v69, v69
    v_exp_f32 v70, v70
    v_exp_f32 v71, v71
    v_exp_f32 v72, v72
    v_exp_f32 v73, v73
    v_exp_f32 v74, v74
    v_exp_f32 v75, v75
    v_smfmac_f32_32x32x32_bf16 v[176:191], v[202:205], v[64:71], v9
    v_exp_f32 v76, v76
    v_exp_f32 v77, v77
    v_exp_f32 v78, v78
    v_exp_f32 v79, v79
    v_exp_f32 v48, v48
    v_exp_f32 v49, v49
    v_smfmac_f32_32x32x32_bf16 v[176:191], v[210:213], v[72:79], v9
    v_exp_f32 v50, v50
    v_exp_f32 v51, v51
    v_exp_f32 v52, v52
    v_mfma_f32_32x32x16_bf16 v[64:79], v[218:221], v[20:23], 0
    v_exp_f32 v53, v53
    v_exp_f32 v54, v54
    v_exp_f32 v55, v55
    v_exp_f32 v56, v56
    v_exp_f32 v57, v57
    v_exp_f32 v58, v58
    v_exp_f32 v59, v59
    v_smfmac_f32_32x32x32_bf16 v[128:143], v[226:229], v[48:55], v9
    v_exp_f32 v60, v60
    v_exp_f32 v61, v61
    v_exp_f32 v62, v62
    v_exp_f32 v63, v63
    v_exp_f32 v64, v64
    v_exp_f32 v65, v65
    v_smfmac_f32_32x32x32_bf16 v[128:143], v[234:237], v[56:63], v9
    s_mov_b64 exec, s[28:29]
    buffer_load_dwordx4 v[202:205], v2, s[4:7], s63 offen offset:2048
    buffer_load_dwordx4 v[210:213], v2, s[4:7], s63 offen offset:2304
    s_mov_b64 exec, -1
    v_exp_f32 v66, v66
    v_exp_f32 v67, v67
    v_exp_f32 v68, v68
    v_mfma_f32_32x32x16_bf16 v[48:63], v[218:221], v[24:27], 0
    v_exp_f32 v69, v69
    v_exp_f32 v70, v70
    v_exp_f32 v71, v71
    v_exp_f32 v72, v72
    v_exp_f32 v73, v73
    v_exp_f32 v74, v74
    v_exp_f32 v75, v75
    v_smfmac_f32_32x32x32_bf16 v[144:159], v[226:229], v[64:71], v9
    s_cbranch_scc1 L_loop
    v_exp_f32 v76, v76
    v_exp_f32 v77, v77
    v_exp_f32 v78, v78
    v_exp_f32 v79, v79
    v_exp_f32 v48, v48
    v_exp_f32 v49, v49
    v_smfmac_f32_32x32x32_bf16 v[144:159], v[234:237], v[72:79], v9
    v_exp_f32 v50, v50
    v_exp_f32 v51, v51
    v_exp_f32 v52, v52
    v_mfma_f32_32x32x16_bf16 v[64:79], v[218:221], v[28:31], 0
    v_exp_f32 v53, v53
    v_exp_f32 v54, v54
    v_exp_f32 v55, v55
    v_exp_f32 v56, v56
    v_exp_f32 v57, v57
    v_exp_f32 v58, v58
    v_exp_f32 v59, v59
    v_smfmac_f32_32x32x32_bf16 v[160:175], v[226:229], v[48:55], v9
    v_exp_f32 v60, v60
    v_exp_f32 v61, v61
    v_exp_f32 v62, v62
    v_exp_f32 v63, v63
    v_exp_f32 v64, v64
    v_exp_f32 v65, v65
    v_smfmac_f32_32x32x32_bf16 v[160:175], v[234:237], v[56:63], v9
    s_waitcnt vmcnt(6)
    v_exp_f32 v66, v66
    v_exp_f32 v67, v67
    v_exp_f32 v68, v68
    v_mfma_f32_32x32x16_bf16 v[48:63], v[82:85], v[16:19], 0
    buffer_load_dwordx4 v[218:221], v3, s[4:7], s63 offen offset:3072
    v_exp_f32 v69, v69
    v_exp_f32 v70, v70
    v_exp_f32 v71, v71
    v_exp_f32 v72, v72
    v_exp_f32 v73, v73
    v_exp_f32 v74, v74
    v_exp_f32 v75, v75
    v_smfmac_f32_32x32x32_bf16 v[176:191], v[226:229], v[64:71], v9
    v_exp_f32 v76, v76
    v_exp_f32 v77, v77
    v_exp_f32 v78, v78
    v_exp_f32 v79, v79
    v_exp_f32 v48, v48
    v_exp_f32 v49, v49
    v_smfmac_f32_32x32x32_bf16 v[176:191], v[234:237], v[72:79], v9
    v_exp_f32 v50, v50
    v_exp_f32 v51, v51
    v_exp_f32 v52, v52
    s_waitcnt vmcnt(4)
    v_mfma_f32_32x32x16_bf16 v[64:79], v[106:109], v[16:19], 0
    s_mov_b64 exec, s[28:29]
    buffer_load_dwordx4 v[226:229], v2, s[4:7], s63 offen offset:3072
    buffer_load_dwordx4 v[234:237], v2, s[4:7], s63 offen offset:3328
    s_mov_b64 exec, -1
    v_exp_f32 v53, v53
    v_exp_f32 v54, v54
    v_exp_f32 v55, v55
    v_exp_f32 v56, v56
    v_exp_f32 v57, v57
    v_exp_f32 v58, v58
    v_exp_f32 v59, v59
    v_smfmac_f32_32x32x32_bf16 v[128:143], v[90:93], v[48:55], v9
    v_exp_f32 v60, v60
    v_exp_f32 v61, v61
    v_exp_f32 v62, v62
    v_exp_f32 v63, v63
    v_exp_f32 v64, v64
    v_exp_f32 v65, v65
    v_smfmac_f32_32x32x32_bf16 v[128:143], v[98:101], v[56:63], v9
    v_exp_f32 v66, v66
    v_exp_f32 v67, v67
    v_exp_f32 v68, v68
    v_mfma_f32_32x32x16_bf16 v[48:63], v[82:85], v[24:27], 0
    v_exp_f32 v69, v69
    v_exp_f32 v70, v70
    v_exp_f32 v71, v71
    v_exp_f32 v72, v72
    v_exp_f32 v73, v73
    v_exp_f32 v74, v74
    v_exp_f32 v75, v75
    v_smfmac_f32_32x32x32_bf16 v[128:143], v[114:117], v[64:71], v9
    v_exp_f32 v76, v76
    v_exp_f32 v77, v77
    v_exp_f32 v78, v78
    v_exp_f32 v79, v79
    v_exp_f32 v48, v48
    v_exp_f32 v49, v49
    v_smfmac_f32_32x32x32_bf16 v[128:143], v[122:125], v[72:79], v9
L_st2800:
    s_cbranch_execz L_st2c00
    v_exp_f32 v50, v50
    v_exp_f32 v51, v51
    v_exp_f32 v52, v52
    s_waitcnt vmcnt(3)
    v_mfma_f32_32x32x16_bf16 v[64:79], v[194:197], v[16:19], 0
    v_exp_f32 v53, v53
    v_exp_f32 v54, v54
    v_exp_f32 v55, v55
    v_exp_f32 v56, v56
    v_exp_f32 v57, v57
    v_exp_f32 v58, v58
    v_exp_f32 v59, v59
    v_smfmac_f32_32x32x32_bf16 v[160:175], v[90:93], v[48:55], v9
    v_exp_f32 v60, v60
    v_exp_f32 v61, v61
    v_exp_f32 v62, v62
    v_exp_f32 v63, v63
    v_exp_f32 v64, v64
    v_exp_f32 v65, v65
    v_smfmac_f32_32x32x32_bf16 v[160:175], v[98:101], v[56:63], v9
    v_exp_f32 v66, v66
    v_exp_f32 v67, v67
    v_exp_f32 v68, v68
    v_mfma_f32_32x32x16_bf16 v[48:63], v[106:109], v[24:27], 0
    v_exp_f32 v69, v69
    v_exp_f32 v70, v70
    v_exp_f32 v71, v71
    v_exp_f32 v72, v72
    v_exp_f32 v73, v73
    v_exp_f32 v74, v74
    v_exp_f32 v75, v75
    v_smfmac_f32_32x32x32_bf16 v[128:143], v[202:205], v[64:71], v9
    v_exp_f32 v76, v76
    v_exp_f32 v77, v77
    v_exp_f32 v78, v78
    v_exp_f32 v79, v79
    v_exp_f32 v48, v48
    v_exp_f32 v49, v49
    v_smfmac_f32_32x32x32_bf16 v[128:143], v[210:213], v[72:79], v9
    v_exp_f32 v50, v50
    v_exp_f32 v51, v51
    v_exp_f32 v52, v52
    s_waitcnt vmcnt(0)
    v_mfma_f32_32x32x16_bf16 v[64:79], v[218:221], v[16:19], 0
    v_exp_f32 v53, v53
    v_exp_f32 v54, v54
    v_exp_f32 v55, v55
    v_exp_f32 v56, v56
    v_exp_f32 v57, v57
    v_exp_f32 v58, v58
    v_exp_f32 v59, v59
    v_smfmac_f32_32x32x32_bf16 v[160:175], v[114:117], v[48:55], v9
    v_exp_f32 v60, v60
    v_exp_f32 v61, v61
    v_exp_f32 v62, v62
    v_exp_f32 v63, v63
    v_exp_f32 v64, v64
    v_exp_f32 v65, v65
    v_smfmac_f32_32x32x32_bf16 v[160:175], v[122:125], v[56:63], v9
    s_mov_b32 s74, 0x53800000
    s_add_u32 s65, s64, 0x4000
    s_add_u32 s66, s64, 0x800000
    s_add_u32 s67, s64, 0x804000
    v_exp_f32 v66, v66
    v_exp_f32 v67, v67
    v_exp_f32 v68, v68
    v_mfma_f32_32x32x16_bf16 v[48:63], v[194:197], v[24:27], 0
    v_exp_f32 v69, v69
    v_exp_f32 v70, v70
    v_exp_f32 v71, v71
    v_exp_f32 v72, v72
    v_exp_f32 v73, v73
    v_exp_f32 v74, v74
    v_exp_f32 v75, v75
    v_smfmac_f32_32x32x32_bf16 v[128:143], v[226:229], v[64:71], v9
    v_exp_f32 v76, v76
    v_exp_f32 v77, v77
    v_exp_f32 v78, v78
    v_exp_f32 v79, v79
    v_exp_f32 v48, v48
    v_exp_f32 v49, v49
    v_smfmac_f32_32x32x32_bf16 v[128:143], v[234:237], v[72:79], v9
    v_exp_f32 v50, v50
    v_exp_f32 v51, v51
    v_exp_f32 v52, v52
    v_mfma_f32_32x32x16_bf16 v[64:79], v[218:221], v[24:27], 0
    v_exp_f32 v53, v53
    v_exp_f32 v54, v54
    v_exp_f32 v55, v55
    v_exp_f32 v56, v56
    v_exp_f32 v57, v57
    v_exp_f32 v58, v58
    v_exp_f32 v59, v59
    v_smfmac_f32_32x32x32_bf16 v[160:175], v[202:205], v[48:55], v9
    ds_write_b128 v6, v[128:131] offset:2048
    v_exp_f32 v60, v60
    ds_write_b128 v6, v[132:135] offset:1024
    v_exp_f32 v61, v61
    ds_write2_b32 v6, v136, v1 offset0:0 offset1:3
    v_exp_f32 v62, v62
    v_exp_f32 v63, v63
    v_exp_f32 v64, v64
    v_exp_f32 v65, v65
    v_smfmac_f32_32x32x32_bf16 v[160:175], v[210:213], v[56:63], v9
    v_exp_f32 v66, v66
    v_exp_f32 v67, v67
    v_exp_f32 v68, v68
    v_mfma_f32_32x32x16_bf16 v[48:63], v[82:85], v[20:23], 0
    v_exp_f32 v69, v69
    v_exp_f32 v70, v70
    v_exp_f32 v71, v71
    s_waitcnt lgkmcnt(0)
    s_barrier
    ds_read_b32 v80, v7
    v_exp_f32 v72, v72
    v_exp_f32 v73, v73
    v_exp_f32 v74, v74
    v_exp_f32 v75, v75
    ds_read_b128 v[240:243], v7 offset:2048
    v_smfmac_f32_32x32x32_bf16 v[160:175], v[226:229], v[64:71], v9
    ds_read_b128 v[244:247], v7 offset:1024
    v_exp_f32 v76, v76
    v_exp_f32 v77, v77
    v_exp_f32 v78, v78
    v_exp_f32 v79, v79
    v_exp_f32 v48, v48
    v_exp_f32 v49, v49
    v_smfmac_f32_32x32x32_bf16 v[160:175], v[234:237], v[72:79], v9
    v_exp_f32 v50, v50
    v_exp_f32 v51, v51
    v_exp_f32 v52, v52
    v_mfma_f32_32x32x16_bf16 v[64:79], v[106:109], v[20:23], 0
    v_exp_f32 v53, v53
    v_exp_f32 v54, v54
    v_exp_f32 v55, v55
    v_exp_f32 v56, v56
    v_exp_f32 v57, v57
    v_exp_f32 v58, v58
    v_exp_f32 v59, v59
    s_waitcnt lgkmcnt(0)
    v_add_f32 v168, v168, v80
    v_rcp_f32 v12, v168
    v_pk_add_f32 v[160:161], v[160:161], v[240:241]
    v_pk_add_f32 v[162:163], v[162:163], v[242:243]
    v_pk_add_f32 v[164:165], v[164:165], v[244:245]
    v_pk_add_f32 v[166:167], v[166:167], v[246:247]
    v_smfmac_f32_32x32x32_bf16 v[144:159], v[90:93], v[48:55], v9
    v_cmp_nge_f32 vcc, s74, v168
    v_pk_mul_f32 v[160:161], v[160:161], v[12:13] op_sel_hi:[1,0]
    v_pk_mul_f32 v[162:163], v[162:163], v[12:13] op_sel_hi:[1,0]
    v_pk_mul_f32 v[164:165], v[164:165], v[12:13] op_sel_hi:[1,0]
    v_pk_mul_f32 v[166:167], v[166:167], v[12:13] op_sel_hi:[1,0]
    v_exp_f32 v60, v60
    v_exp_f32 v61, v61
    v_cvt_pk_bf16_f32 v16, v160, v161
    v_cvt_pk_bf16_f32 v17, v162, v163
    v_cvt_pk_bf16_f32 v18, v164, v165
    v_cvt_pk_bf16_f32 v19, v166, v167
    s_or_b64 s[68:69], vcc, vcc
    s_cbranch_scc1 L_noe
    buffer_store_dwordx4 v[16:19], v5, s[4:7], s64 offen
    buffer_store_dwordx4 v[16:19], v5, s[4:7], s66 offen sc1
L_noe:
    v_exp_f32 v62, v62
    v_exp_f32 v63, v63
    v_exp_f32 v64, v64
    v_exp_f32 v65, v65
    v_smfmac_f32_32x32x32_bf16 v[144:159], v[98:101], v[56:63], v9
    v_exp_f32 v66, v66
    v_exp_f32 v67, v67
    v_exp_f32 v68, v68
    v_mfma_f32_32x32x16_bf16 v[48:63], v[82:85], v[28:31], 0
    v_exp_f32 v69, v69
    v_exp_f32 v70, v70
    v_exp_f32 v71, v71
    v_exp_f32 v72, v72
    v_exp_f32 v73, v73
    v_exp_f32 v74, v74
    v_exp_f32 v75, v75
    v_smfmac_f32_32x32x32_bf16 v[144:159], v[114:117], v[64:71], v9
    v_exp_f32 v76, v76
    v_exp_f32 v77, v77
    v_exp_f32 v78, v78
    v_exp_f32 v79, v79
    v_exp_f32 v48, v48
    v_exp_f32 v49, v49
    v_smfmac_f32_32x32x32_bf16 v[144:159], v[122:125], v[72:79], v9
    v_exp_f32 v50, v50
    v_exp_f32 v51, v51
    v_exp_f32 v52, v52
    v_mfma_f32_32x32x16_bf16 v[64:79], v[194:197], v[20:23], 0
    v_exp_f32 v53, v53
    v_exp_f32 v54, v54
    v_exp_f32 v55, v55
    v_exp_f32 v56, v56
    v_exp_f32 v57, v57
    v_exp_f32 v58, v58
    v_exp_f32 v59, v59
    v_smfmac_f32_32x32x32_bf16 v[176:191], v[90:93], v[48:55], v9
    v_exp_f32 v60, v60
    v_exp_f32 v61, v61
    v_exp_f32 v62, v62
    v_exp_f32 v63, v63
    v_exp_f32 v64, v64
    v_exp_f32 v65, v65
    v_smfmac_f32_32x32x32_bf16 v[176:191], v[98:101], v[56:63], v9
L_st2c00:
    s_cbranch_execz L_tyr
    v_exp_f32 v66, v66
    v_exp_f32 v67, v67
    v_exp_f32 v68, v68
    v_mfma_f32_32x32x16_bf16 v[48:63], v[106:109], v[28:31], 0
    v_exp_f32 v69, v69
    v_exp_f32 v70, v70
    v_exp_f32 v71, v71
    v_exp_f32 v72, v72
    v_exp_f32 v73, v73
    v_exp_f32 v74, v74
    v_exp_f32 v75, v75
    v_smfmac_f32_32x32x32_bf16 v[144:159], v[202:205], v[64:71], v9
    v_exp_f32 v76, v76
    v_exp_f32 v77, v77
    v_exp_f32 v78, v78
    v_exp_f32 v79, v79
    v_exp_f32 v48, v48
    v_exp_f32 v49, v49
    v_smfmac_f32_32x32x32_bf16 v[144:159], v[210:213], v[72:79], v9
    v_exp_f32 v50, v50
    v_exp_f32 v51, v51
    v_exp_f32 v52, v52
    s_barrier
    v_mfma_f32_32x32x16_bf16 v[64:79], v[218:221], v[20:23], 0
    v_exp_f32 v53, v53
    v_exp_f32 v54, v54
    v_exp_f32 v55, v55
    v_exp_f32 v56, v56
    v_exp_f32 v57, v57
    v_exp_f32 v58, v58
    v_exp_f32 v59, v59
    v_smfmac_f32_32x32x32_bf16 v[176:191], v[114:117], v[48:55], v9
    v_exp_f32 v60, v60
    v_exp_f32 v61, v61
    v_exp_f32 v62, v62
    v_exp_f32 v63, v63
    v_exp_f32 v64, v64
    v_exp_f32 v65, v65
    v_smfmac_f32_32x32x32_bf16 v[176:191], v[122:125], v[56:63], v9
    v_exp_f32 v66, v66
    v_exp_f32 v67, v67
    v_exp_f32 v68, v68
    v_mfma_f32_32x32x16_bf16 v[48:63], v[194:197], v[28:31], 0
    v_exp_f32 v69, v69
    v_exp_f32 v70, v70
    v_exp_f32 v71, v71
    v_exp_f32 v72, v72
    v_exp_f32 v73, v73
    v_exp_f32 v74, v74
    v_exp_f32 v75, v75
    v_smfmac_f32_32x32x32_bf16 v[144:159], v[226:229], v[64:71], v9
    v_exp_f32 v76, v76
    v_exp_f32 v77, v77
    v_exp_f32 v78, v78
    v_exp_f32 v79, v79
    v_exp_f32 v48, v48
    v_exp_f32 v49, v49
    v_smfmac_f32_32x32x32_bf16 v[144:159], v[234:237], v[72:79], v9
    v_exp_f32 v50, v50
    v_exp_f32 v51, v51
    v_exp_f32 v52, v52
    v_mfma_f32_32x32x16_bf16 v[64:79], v[218:221], v[28:31], 0
    v_exp_f32 v53, v53
    v_exp_f32 v54, v54
    v_exp_f32 v55, v55
    v_exp_f32 v56, v56
    v_exp_f32 v57, v57
    v_exp_f32 v58, v58
    v_exp_f32 v59, v59
    v_smfmac_f32_32x32x32_bf16 v[176:191], v[202:205], v[48:55], v9
    ds_write_b128 v6, v[144:147] offset:3072
    v_exp_f32 v60, v60
    ds_write_b128 v6, v[148:151] offset:4096
    v_exp_f32 v61, v61
    ds_write2_b32 v6, v152, v9 offset0:2 offset1:3
    v_exp_f32 v62, v62
    v_exp_f32 v63, v63
    v_exp_f32 v64, v64
    v_exp_f32 v65, v65
    v_smfmac_f32_32x32x32_bf16 v[176:191], v[210:213], v[56:63], v9
    v_exp_f32 v66, v66
    v_exp_f32 v67, v67
    v_exp_f32 v68, v68
    v_exp_f32 v69, v69
    v_exp_f32 v70, v70
    v_exp_f32 v71, v71
    v_exp_f32 v72, v72
    v_exp_f32 v73, v73
    v_exp_f32 v74, v74
    v_exp_f32 v75, v75
    ds_read_b64 v[86:87], v7 offset:8
    ds_read_b128 v[248:251], v7 offset:3072
    v_smfmac_f32_32x32x32_bf16 v[176:191], v[226:229], v[64:71], v9
    ds_read_b128 v[252:255], v7 offset:4096
    v_exp_f32 v76, v76
    v_exp_f32 v77, v77
    v_exp_f32 v78, v78
    v_exp_f32 v79, v79
    s_waitcnt lgkmcnt(2)
    v_cmp_eq_u32 vcc, 0, v87
    v_smfmac_f32_32x32x32_bf16 v[176:191], v[234:237], v[72:79], v9
    s_cbranch_vccnz L_pr
L_pd:
    s_waitcnt lgkmcnt(0)
    s_nop 9
    v_add_f32 v184, v184, v86
    v_rcp_f32 v12, v184
    v_cmp_nge_f32 vcc, s74, v184
    v_pk_add_f32 v[176:177], v[176:177], v[248:249]
    v_pk_add_f32 v[178:179], v[178:179], v[250:251]
    v_pk_add_f32 v[180:181], v[180:181], v[252:253]
    v_pk_add_f32 v[182:183], v[182:183], v[254:255]
    s_or_b64 s[68:69], s[68:69], vcc
    s_cbranch_scc1 L_fallback
L_fin:
    v_pk_mul_f32 v[176:177], v[176:177], v[12:13] op_sel_hi:[1,0]
    v_pk_mul_f32 v[178:179], v[178:179], v[12:13] op_sel_hi:[1,0]
    v_pk_mul_f32 v[180:181], v[180:181], v[12:13] op_sel_hi:[1,0]
    v_pk_mul_f32 v[182:183], v[182:183], v[12:13] op_sel_hi:[1,0]
    v_cvt_pk_bf16_f32 v20, v176, v177
    v_cvt_pk_bf16_f32 v21, v178, v179
    v_cvt_pk_bf16_f32 v22, v180, v181
    v_cvt_pk_bf16_f32 v23, v182, v183
    buffer_store_dwordx4 v[20:23], v5, s[4:7], s65 offen
    buffer_store_dwordx4 v[20:23], v5, s[4:7], s67 offen sc1
    s_barrier
L_end:
    s_endpgm
L_r0:
    s_waitcnt lgkmcnt(0)
    s_add_u32 s32, s76, 0x60000
    s_add_u32 s33, s32, 4096
    v_cndmask_b32 v15, 0, -1, s[28:29]
    buffer_load_dwordx4 v[80:83], v3, s[4:7], s32 offen offset:0 sc1
    buffer_load_dwordx4 v[84:87], v3, s[4:7], s32 offen offset:1024 sc1
    s_mov_b64 exec, s[28:29]
    buffer_load_dwordx4 v[88:91], v3, s[4:7], s33 offen offset:0 sc1
    buffer_load_dwordx4 v[92:95], v3, s[4:7], s33 offen offset:1024 sc1
    buffer_load_dwordx4 v[96:99], v3, s[4:7], s33 offen offset:256 sc1
    buffer_load_dwordx4 v[100:103], v3, s[4:7], s33 offen offset:1280 sc1
    s_mov_b64 exec, -1
    buffer_load_dwordx4 v[104:107], v3, s[4:7], s32 offen offset:2048 sc1
    buffer_load_dwordx4 v[108:111], v3, s[4:7], s32 offen offset:3072 sc1
    s_mov_b64 exec, s[28:29]
    buffer_load_dwordx4 v[112:115], v3, s[4:7], s33 offen offset:2048 sc1
    buffer_load_dwordx4 v[116:119], v3, s[4:7], s33 offen offset:3072 sc1
    buffer_load_dwordx4 v[120:123], v3, s[4:7], s33 offen offset:2304 sc1
    buffer_load_dwordx4 v[124:127], v3, s[4:7], s33 offen offset:3328 sc1
    s_mov_b64 exec, -1
    ds_read_u8 v14, v4 offset:17
    s_waitcnt vmcnt(0) lgkmcnt(0)
    v_bitop3_b32 v94, v94, v88, v96 bitop3:0x7e
    v_bitop3_b32 v102, v102, v88, s60 bitop3:0x7e
    v_bitop3_b32 v80, v80, v86, s60 bitop3:0x7e
    v_bitop3_b32 v95, v95, v89, v97 bitop3:0x7e
    v_bitop3_b32 v103, v103, v89, s61 bitop3:0x7e
    v_bitop3_b32 v81, v81, v87, s61 bitop3:0x7e
    v_bitop3_b32 v118, v118, v112, v120 bitop3:0x7e
    v_bitop3_b32 v126, v126, v112, s60 bitop3:0x7e
    v_bitop3_b32 v104, v104, v110, s60 bitop3:0x7e
    v_bitop3_b32 v119, v119, v113, v121 bitop3:0x7e
    v_bitop3_b32 v127, v127, v113, s61 bitop3:0x7e
    v_bitop3_b32 v105, v105, v111, s61 bitop3:0x7e
    v_or3_b32 v8, v94, v102, v95
    v_or3_b32 v8, v8, v103, v118
    v_or3_b32 v8, v8, v126, v119
    v_bitop3_b32 v8, v8, v127, v15 bitop3:0xa8
    v_or3_b32 v8, v8, v80, v81
    v_or3_b32 v8, v8, v104, v105
    v_cmp_ne_u32 vcc, 0, v8
    s_cbranch_vccz L_rx0
    v_and_b32 v14, 4, v14
    v_cmp_eq_u32 vcc, 0, v14
    s_cbranch_vccnz L_r0
    buffer_load_dwordx4 v[82:85], v3, s[4:7], s37 offen offset:0 sc1
    s_mov_b64 exec, s[28:29]
    buffer_load_dwordx4 v[90:93], v2, s[4:7], s37 offen offset:0 sc1
    buffer_load_dwordx4 v[98:101], v2, s[4:7], s37 offen offset:256 sc1
    s_mov_b64 exec, -1
    buffer_load_dwordx4 v[106:109], v3, s[4:7], s37 offen offset:1024 sc1
    s_mov_b64 exec, s[28:29]
    buffer_load_dwordx4 v[114:117], v2, s[4:7], s37 offen offset:1024 sc1
    buffer_load_dwordx4 v[122:125], v2, s[4:7], s37 offen offset:1280 sc1
    s_mov_b64 exec, -1
L_st3000:
    s_cbranch_execz L_tzr
    s_waitcnt vmcnt(0)
L_rx0:
    v_mfma_f32_32x32x16_bf16 v[48:63], v[82:85], v[16:19], 0
    s_nop 10
    s_branch L_c0
L_pr:
    ds_read_b64 v[86:87], v7 offset:8
    ds_read_b128 v[248:251], v7 offset:3072
    ds_read_b128 v[252:255], v7 offset:4096
    s_waitcnt lgkmcnt(0)
    v_cmp_eq_u32 vcc, 0, v87
    s_cbranch_vccnz L_pr
    s_branch L_pd
L_l2x:
    ds_read_u8 v12, v4 offset:17
    s_waitcnt lgkmcnt(0)
    v_cmp_ne_u32 vcc, 4, v12
    s_cbranch_vccnz L_l2x
    buffer_load_dwordx4 v[194:197], v3, s[4:7], s37 offen offset:2048 sc1
    s_mov_b64 exec, s[28:29]
    buffer_load_dwordx4 v[202:205], v2, s[4:7], s37 offen offset:2048 sc1
    buffer_load_dwordx4 v[210:213], v2, s[4:7], s37 offen offset:2304 sc1
    s_mov_b64 exec, -1
    buffer_load_dwordx4 v[218:221], v3, s[4:7], s37 offen offset:3072 sc1
    s_mov_b64 exec, s[28:29]
    buffer_load_dwordx4 v[226:229], v2, s[4:7], s37 offen offset:3072 sc1
    buffer_load_dwordx4 v[234:237], v2, s[4:7], s37 offen offset:3328 sc1
    s_mov_b64 exec, -1
    s_waitcnt vmcnt(0)
    s_branch L_l2d
L_X2:
    s_mov_b64 s[8:9], s[26:27]
    s_lshl1_add_u32 s56, s48, s53
    s_lshl1_add_u32 s57, s47, s52
    s_lshl_b32 s54, s56, 15
    s_lshl_b32 s55, s57, 6
    s_add_u32 s54, s54, s55
    s_lshl_b32 s57, s57, 17
    s_lshl_b32 s56, s56, 7
    s_add_u32 s56, s56, s57
    s_add_u32 s56, s56, 0x600000
    s_add_u32 s58, s56, 0x10000
    s_mul_i32 s55, s63, 16320
    s_add_u32 m0, s55, 16384
    s_mov_b64 s[12:13], s[24:25]
    s_mov_b32 s75, 0x05040100
    s_mov_b32 s76, 0x07060302
    v_pk_mov_b32 v[24:25], -1, -1
    v_pk_mov_b32 v[26:27], -1, -1
    s_setprio 3
    s_mov_b64 exec, 0
    s_cmp_eq_u32 s63, 0
    s_cbranch_scc1 L_st2000
    s_cmp_eq_u32 s63, 1
    s_cbranch_scc1 L_st4000
    s_cmp_eq_u32 s63, 2
    s_cbranch_scc1 L_st2800
    s_cmp_eq_u32 s63, 3
    s_cbranch_scc1 L_st3440
L_tyr:
    s_mov_b64 exec, -1
    s_setprio 0
    ds_write_addtid_b32 v64 offset:49152
    ds_write_addtid_b32 v65 offset:49424
    ds_write_addtid_b32 v66 offset:49696
    ds_write_addtid_b32 v67 offset:49968
    ds_write_addtid_b32 v68 offset:50240
    ds_write_addtid_b32 v69 offset:50512
    ds_write_addtid_b32 v70 offset:50784
    ds_write_addtid_b32 v71 offset:51056
    ds_write_addtid_b32 v72 offset:51328
    ds_write_addtid_b32 v73 offset:51600
    ds_write_addtid_b32 v74 offset:51872
    ds_write_addtid_b32 v75 offset:52144
    ds_write_addtid_b32 v76 offset:52416
    ds_write_addtid_b32 v77 offset:52688
    ds_write_addtid_b32 v78 offset:52960
    ds_write_addtid_b32 v79 offset:53232
    ds_write_addtid_b32 v80 offset:53504
    ds_write_addtid_b32 v81 offset:53776
    ds_write_addtid_b32 v82 offset:54048
    ds_write_addtid_b32 v83 offset:54320
    ds_write_addtid_b32 v84 offset:54592
    ds_write_addtid_b32 v85 offset:54864
    ds_write_addtid_b32 v86 offset:55136
    ds_write_addtid_b32 v87 offset:55408
    ds_write_addtid_b32 v88 offset:55680
    ds_write_addtid_b32 v89 offset:55952
    ds_write_addtid_b32 v90 offset:56224
    ds_write_addtid_b32 v91 offset:56496
    ds_write_addtid_b32 v92 offset:56768
    ds_write_addtid_b32 v93 offset:57040
    ds_write_addtid_b32 v94 offset:57312
    ds_write_addtid_b32 v95 offset:57584
    ds_write_addtid_b32 v96 offset:57856
    ds_write_addtid_b32 v97 offset:58128
    ds_write_addtid_b32 v98 offset:58400
    ds_write_addtid_b32 v99 offset:58672
    ds_write_addtid_b32 v100 offset:58944
    ds_write_addtid_b32 v101 offset:59216
    ds_write_addtid_b32 v102 offset:59488
    ds_write_addtid_b32 v103 offset:59760
    ds_write_addtid_b32 v104 offset:60032
    ds_write_addtid_b32 v105 offset:60304
    ds_write_addtid_b32 v106 offset:60576
    ds_write_addtid_b32 v107 offset:60848
    ds_write_addtid_b32 v108 offset:61120
    ds_write_addtid_b32 v109 offset:61392
    ds_write_addtid_b32 v110 offset:61664
    ds_write_addtid_b32 v111 offset:61936
    ds_write_addtid_b32 v112 offset:62208
    ds_write_addtid_b32 v113 offset:62480
    ds_write_addtid_b32 v114 offset:62752
    ds_write_addtid_b32 v115 offset:63024
    ds_write_addtid_b32 v116 offset:63296
    ds_write_addtid_b32 v117 offset:63568
    ds_write_addtid_b32 v118 offset:63840
    ds_write_addtid_b32 v119 offset:64112
    ds_write_addtid_b32 v120 offset:64384
    ds_write_addtid_b32 v121 offset:64656
    ds_write_addtid_b32 v122 offset:64928
    ds_write_addtid_b32 v123 offset:65200
    ds_write_b128 v211, v[224:227] offset:47104
    s_waitcnt lgkmcnt(0)
    s_mov_b64 exec, 1
    ds_add_u32 v4, v3 offset:4
    s_mov_b64 exec, -1
    s_cmp_lg_u32 s22, 0
    s_cbranch_scc1 L_f2d
    s_movk_i32 s62, 0x7fff
L_f2:
    buffer_load_dwordx2 v[248:249], v250, s[4:7], s77 offen sc1
    s_sub_u32 s62, s62, 1
    s_waitcnt vmcnt(0)
    s_cbranch_scc1 L_f2k
    v_cmp_ne_u64 s[70:71], v[22:23], v[248:249]
    s_sleep 1
    s_cmp_lg_u64 s[70:71], 0
    s_cbranch_scc1 L_f2
L_f2k:
    s_mov_b64 exec, 1
    v_mov_b32 v13, 0x100
    ds_add_u32 v4, v13 offset:16
    s_mov_b64 exec, -1
L_f2d:
    buffer_load_dword v240, v8, s[8:11], s54 offen offset:0
    buffer_load_dword v241, v8, s[8:11], s54 offen offset:1024
    buffer_load_dword v242, v8, s[8:11], s54 offen offset:2048
    buffer_load_dword v243, v8, s[8:11], s54 offen offset:3072
    buffer_load_dword v244, v8, s[8:11], s54 offen offset:32
    buffer_load_dword v245, v8, s[8:11], s54 offen offset:1056
    buffer_load_dword v246, v8, s[8:11], s54 offen offset:2080
    buffer_load_dword v247, v8, s[8:11], s54 offen offset:3104
L_lw_2:
    ds_read_b32 v7, v4 offset:4
    s_waitcnt lgkmcnt(0)
    v_readfirstlane_b32 s59, v7
    s_cmp_ge_u32 s59, 4
    s_cbranch_scc1 L_lwd_3
    s_sleep 1
    s_branch L_lw_2
L_lwd_3:
    s_setprio 0
    ds_read_b128 v[64:67], v206 offset:0
    ds_read_b128 v[68:71], v204 offset:0
    ds_read_b128 v[72:75], v206 offset:32
    ds_read_b128 v[76:79], v204 offset:32
    ds_read_b128 v[80:83], v206 offset:64
    ds_read_b128 v[84:87], v204 offset:64
    ds_read_b128 v[88:91], v206 offset:96
    ds_read_b128 v[92:95], v204 offset:96
    s_waitcnt lgkmcnt(6)
    v_mfma_f32_32x32x16_bf16 v[32:47], v[68:71], v[64:67], 0
    ds_read_b128 v[96:99], v206 offset:128
    ds_read_b128 v[100:103], v204 offset:128
L_st3440:
    s_cbranch_execz L_tyr
    s_waitcnt lgkmcnt(6)
    v_mfma_f32_32x32x16_bf16 v[32:47], v[76:79], v[72:75], v[32:47]
    ds_read_b128 v[104:107], v206 offset:160
    ds_read_b128 v[108:111], v204 offset:160
    s_waitcnt lgkmcnt(6)
    v_mfma_f32_32x32x16_bf16 v[32:47], v[84:87], v[80:83], v[32:47]
    ds_read_b128 v[64:67], v206 offset:192
    ds_read_b128 v[68:71], v204 offset:192
    s_waitcnt lgkmcnt(6)
    v_mfma_f32_32x32x16_bf16 v[32:47], v[92:95], v[88:91], v[32:47]
    ds_read_b128 v[72:75], v206 offset:224
    ds_read_b128 v[76:79], v204 offset:224
    s_waitcnt lgkmcnt(6)
    v_mfma_f32_32x32x16_bf16 v[32:47], v[100:103], v[96:99], v[32:47]
    ds_read_b128 v[80:83], v206 offset:16320
    ds_read_b128 v[84:87], v204 offset:16320
    s_waitcnt lgkmcnt(6)
    v_mfma_f32_32x32x16_bf16 v[32:47], v[108:111], v[104:107], v[32:47]
    ds_read_b128 v[88:91], v206 offset:16352
    ds_read_b128 v[92:95], v204 offset:16352
    s_waitcnt lgkmcnt(6)
    v_mfma_f32_32x32x16_bf16 v[32:47], v[68:71], v[64:67], v[32:47]
    ds_read_b128 v[96:99], v206 offset:16384
    ds_read_b128 v[100:103], v204 offset:16384
    s_waitcnt lgkmcnt(6)
    v_mfma_f32_32x32x16_bf16 v[32:47], v[76:79], v[72:75], v[32:47]
    ds_read_b128 v[104:107], v206 offset:16416
    ds_read_b128 v[108:111], v204 offset:16416
    s_waitcnt lgkmcnt(6)
    v_mfma_f32_32x32x16_bf16 v[32:47], v[84:87], v[80:83], v[32:47]
    ds_read_b128 v[64:67], v206 offset:16448
    ds_read_b128 v[68:71], v204 offset:16448
    s_waitcnt lgkmcnt(6)
    v_mfma_f32_32x32x16_bf16 v[32:47], v[92:95], v[88:91], v[32:47]
    ds_read_b128 v[72:75], v206 offset:16480
    ds_read_b128 v[76:79], v204 offset:16480
    s_waitcnt lgkmcnt(6)
    v_mfma_f32_32x32x16_bf16 v[32:47], v[100:103], v[96:99], v[32:47]
    ds_read_b128 v[80:83], v206 offset:16512
    ds_read_b128 v[84:87], v204 offset:16512
    s_waitcnt lgkmcnt(6)
    v_mfma_f32_32x32x16_bf16 v[32:47], v[108:111], v[104:107], v[32:47]
    ds_read_b128 v[88:91], v206 offset:16544
    ds_read_b128 v[92:95], v204 offset:16544
    s_waitcnt lgkmcnt(6)
    v_mfma_f32_32x32x16_bf16 v[32:47], v[68:71], v[64:67], v[32:47]
    s_waitcnt lgkmcnt(4)
    v_mfma_f32_32x32x16_bf16 v[32:47], v[76:79], v[72:75], v[32:47]
    s_waitcnt lgkmcnt(2)
    v_mfma_f32_32x32x16_bf16 v[32:47], v[84:87], v[80:83], v[32:47]
    s_waitcnt lgkmcnt(0)
    v_mfma_f32_32x32x16_bf16 v[32:47], v[92:95], v[88:91], v[32:47]
    s_waitcnt vmcnt(0)
    buffer_store_dwordx4 v[240:243], v209, s[4:7], s56 offen sc1
    buffer_store_dwordx4 v[244:247], v209, s[4:7], s58 offen sc1
    s_nop 7
    s_setprio 3
    s_cmp_lg_u32 s53, 0
    v_cndmask_b32 v16, v44, v45, s[68:69]
    v_cndmask_b32 v17, v46, v47, s[68:69]
    s_cbranch_scc1 L_kodd
    v_add_f32 v32, v32, v220
    v_cvt_pk_bf16_f32 v48, v32, v33
    v_cvt_pk_bf16_f32 v49, v34, v35
    v_cvt_pk_bf16_f32 v50, v36, v37
    v_cvt_pk_bf16_f32 v51, v38, v39
    ds_write_b128 v207, v[48:51] offset:0
    v_cvt_pk_bf16_f32 v52, v41, v41
    v_cvt_pk_bf16_f32 v53, v41, v42
    v_cvt_pk_bf16_f32 v54, v42, v42
    v_cvt_pk_bf16_f32 v55, v43, v43
    ds_write_b128 v207, v[52:55] offset:1024
    v_cvt_pk_bf16_f32 v56, v44, v44
    v_cvt_pk_bf16_f32 v57, v44, v44
    v_cvt_pk_bf16_f32 v58, v16, v45
    v_cvt_pk_bf16_f32 v59, v45, v45
    ds_write_b128 v207, v[56:59] offset:2048
    v_cvt_pk_bf16_f32 v60, v46, v46
    v_cvt_pk_bf16_f32 v61, v46, v46
    v_cvt_pk_bf16_f32 v62, v17, v47
    v_cvt_pk_bf16_f32 v63, v47, v47
    ds_write_b128 v207, v[60:63] offset:3072
    v_lshlrev_b32 v17, 16, v48
    v_cndmask_b32 v17, 0, v17, vcc
    s_mov_b32 exec_hi, 0
    ds_write_b32 v208, v17
    s_mov_b32 exec_hi, -1
    s_branch L_nopad
L_kodd:
    v_cvt_pk_bf16_f32 v48, v33, v34
    v_cvt_pk_bf16_f32 v49, v35, v36
    v_cvt_pk_bf16_f32 v50, v37, v38
    v_cvt_pk_bf16_f32 v51, v39, v40
    ds_write_b128 v207, v[48:51] offset:0
    v_cvt_pk_bf16_f32 v52, v41, v41
    v_cvt_pk_bf16_f32 v53, v42, v42
    v_cvt_pk_bf16_f32 v54, v42, v43
    v_cvt_pk_bf16_f32 v55, v43, v43
    ds_write_b128 v207, v[52:55] offset:1024
    v_cvt_pk_bf16_f32 v56, v44, v44
    v_cvt_pk_bf16_f32 v57, v44, v16
    v_cvt_pk_bf16_f32 v58, v45, v45
    v_cvt_pk_bf16_f32 v59, v45, v45
    ds_write_b128 v207, v[56:59] offset:2048
    v_cvt_pk_bf16_f32 v60, v46, v46
    v_cvt_pk_bf16_f32 v61, v46, v17
    v_cvt_pk_bf16_f32 v62, v47, v47
    v_cvt_pk_bf16_f32 v63, v47, v47
    ds_write_b128 v207, v[60:63] offset:3072
L_nopad:
    s_lshl_b32 s57, s63, 14
    s_add_u32 s57, s57, 65536
    s_lshl_b32 s56, s63, 17
    s_lshl_b32 s54, s50, 7
    s_add_u32 s56, s56, s54
    s_lshl_b32 s77, s47, 12
    s_add_u32 s77, s77, 0x50000
    s_lshl2_add_u32 s55, s51, s63
    s_lshl_b32 s74, s55, 11
    s_add_u32 s55, s74, 0x600000
    v_lshlrev_b32 v13, 5, v0
    s_waitcnt vmcnt(0) lgkmcnt(0)
    s_mov_b64 exec, 1
    ds_add_u32 v4, v3 offset:4
    s_mov_b64 exec, -1
    s_cmp_lg_u32 s63, 0
    s_cbranch_scc1 L_guw
L_lw_4:
    ds_read_b32 v7, v4 offset:4
    s_waitcnt lgkmcnt(0)
    v_readfirstlane_b32 s59, v7
    s_cmp_ge_u32 s59, 8
    s_cbranch_scc1 L_lwd_5
    s_sleep 1
    s_branch L_lw_4
L_lwd_5:
    s_lshl_b32 s54, s48, 7
    s_add_u32 s54, s54, s77
    s_mov_b64 exec, 1
    buffer_store_dwordx2 v[22:23], v1, s[4:7], s54 offen offset:0 sc1
    s_mov_b64 exec, -1
    s_mov_b32 s62, 65536
    s_sleep 8
L_gu:
    buffer_load_dwordx2 v[18:19], v222, s[4:7], s77 offen offset:0 sc1
    s_sub_u32 s62, s62, 1
    s_waitcnt vmcnt(0)
    s_cbranch_scc1 L_gud
    v_cmp_ne_u64 vcc, v[22:23], v[18:19]
    s_cbranch_vccz L_gud
    s_sleep 8
    s_branch L_gu
L_gud:
    s_mov_b64 exec, 1
    ds_add_u32 v4, v3 offset:20
    s_mov_b64 exec, -1
    s_branch L_gue
L_guw:
L_lw_6:
    ds_read_b32 v7, v4 offset:20
    s_waitcnt lgkmcnt(0)
    v_readfirstlane_b32 s59, v7
    s_cmp_ge_u32 s59, 1
    s_cbranch_scc1 L_lwd_7
    s_sleep 4
    s_branch L_lw_6
L_lwd_7:
L_gue:
    buffer_load_dwordx4 v[240:243], v13, s[4:7], s55 offen sc1
    buffer_load_dwordx4 v[244:247], v13, s[4:7], s55 offen offset:16 sc1
    s_waitcnt vmcnt(0)
    v_perm_b32 v64, v246, v247, s75
    v_perm_b32 v65, v244, v245, s75
    v_perm_b32 v66, v242, v243, s75
    v_perm_b32 v67, v240, v241, s75
    v_perm_b32 v68, v246, v247, s76
    v_perm_b32 v69, v244, v245, s76
    v_perm_b32 v70, v242, v243, s76
    v_perm_b32 v71, v240, v241, s76
    ds_write_b128 v210, v[64:67]
    ds_write_b128 v210, v[68:71] offset:16384
    s_waitcnt lgkmcnt(0)
    s_mov_b64 exec, 1
    ds_add_u32 v4, v3 offset:4
    s_mov_b64 exec, -1
L_lw_8:
    ds_read_b32 v7, v4 offset:4
    s_waitcnt lgkmcnt(0)
    v_readfirstlane_b32 s59, v7
    s_cmp_ge_u32 s59, 12
    s_cbranch_scc1 L_lwd_9
    s_sleep 1
    s_branch L_lw_8
L_lwd_9:
    s_setprio 0
    ds_read2_b32 v[64:65], v212 offset0:0 offset1:1
    ds_read2_b32 v[66:67], v212 offset0:2 offset1:3
    ds_read_b128 v[124:127], v216 offset:0
    ds_read_b128 v[120:123], v216 offset:512
    ds_read_b128 v[116:119], v216 offset:1024
    ds_read_b128 v[112:115], v216 offset:1536
    ds_read_b128 v[108:111], v216 offset:2048
    ds_read_b128 v[104:107], v216 offset:2560
    ds_read_b128 v[100:103], v216 offset:3072
    ds_read_b128 v[96:99], v216 offset:3584
    ds_read2_b32 v[68:69], v212 offset0:128 offset1:129
    ds_read2_b32 v[70:71], v212 offset0:130 offset1:131
    s_waitcnt lgkmcnt(9)
    v_mfma_f32_16x16x32_bf16 v[60:63], v[64:67], v[124:127], 0
    ds_read2_b32 v[72:73], v213 offset0:0 offset1:1
    s_waitcnt lgkmcnt(9)
    v_mfma_f32_16x16x32_bf16 v[56:59], v[64:67], v[120:123], 0
    ds_read2_b32 v[74:75], v213 offset0:2 offset1:3
    s_waitcnt lgkmcnt(9)
    v_mfma_f32_16x16x32_bf16 v[52:55], v[64:67], v[116:119], 0
    ds_read2_b32 v[76:77], v213 offset0:128 offset1:129
    s_waitcnt lgkmcnt(9)
    v_mfma_f32_16x16x32_bf16 v[48:51], v[64:67], v[112:115], 0
    ds_read2_b32 v[78:79], v213 offset0:130 offset1:131
    s_waitcnt lgkmcnt(9)
    v_mfma_f32_16x16x32_bf16 v[44:47], v[64:67], v[108:111], 0
    ds_read2_b32 v[80:81], v214 offset0:0 offset1:1
    s_add_u32 m0, s57, 0
    s_add_u32 s55, s56, 0
    buffer_load_dwordx4 v14, s[12:15], s55 offen offset:0 lds
    s_waitcnt lgkmcnt(9)
    v_mfma_f32_16x16x32_bf16 v[40:43], v[64:67], v[104:107], 0
    ds_read2_b32 v[82:83], v214 offset0:2 offset1:3
    s_waitcnt lgkmcnt(9)
    v_mfma_f32_16x16x32_bf16 v[36:39], v[64:67], v[100:103], 0
    ds_read2_b32 v[84:85], v214 offset0:128 offset1:129
    s_waitcnt lgkmcnt(9)
    v_mfma_f32_16x16x32_bf16 v[32:35], v[64:67], v[96:99], 0
    ds_read2_b32 v[86:87], v214 offset0:130 offset1:131
    s_waitcnt lgkmcnt(8)
    v_mfma_f32_16x16x32_bf16 v[60:63], v[68:71], v[120:123], v[60:63]
    ds_read2_b32 v[88:89], v215 offset0:0 offset1:1
    v_mfma_f32_16x16x32_bf16 v[56:59], v[68:71], v[116:119], v[56:59]
    ds_read2_b32 v[90:91], v215 offset0:2 offset1:3
    v_mfma_f32_16x16x32_bf16 v[52:55], v[68:71], v[112:115], v[52:55]
    ds_read2_b32 v[92:93], v215 offset0:128 offset1:129
    v_mfma_f32_16x16x32_bf16 v[48:51], v[68:71], v[108:111], v[48:51]
    ds_read2_b32 v[94:95], v215 offset0:130 offset1:131
    v_mfma_f32_16x16x32_bf16 v[44:47], v[68:71], v[104:107], v[44:47]
    ds_read2_b32 v[128:129], v212 offset0:32 offset1:33
    v_mfma_f32_16x16x32_bf16 v[40:43], v[68:71], v[100:103], v[40:43]
    ds_read2_b32 v[130:131], v212 offset0:34 offset1:35
    s_add_u32 s55, s56, 7168
    buffer_load_dwordx4 v14, s[12:15], s55 offen offset:1024 lds
    v_mfma_f32_16x16x32_bf16 v[36:39], v[68:71], v[96:99], v[36:39]
    ds_read_b128 v[188:191], v216 offset:128
    s_waitcnt lgkmcnt(13)
    v_mfma_f32_16x16x32_bf16 v[60:63], v[72:75], v[116:119], v[60:63]
    ds_read_b128 v[184:187], v216 offset:640
    v_mfma_f32_16x16x32_bf16 v[56:59], v[72:75], v[112:115], v[56:59]
    ds_read_b128 v[180:183], v216 offset:1152
    v_mfma_f32_16x16x32_bf16 v[52:55], v[72:75], v[108:111], v[52:55]
    ds_read_b128 v[176:179], v216 offset:1664
    v_mfma_f32_16x16x32_bf16 v[48:51], v[72:75], v[104:107], v[48:51]
    ds_read_b128 v[172:175], v216 offset:2176
    v_mfma_f32_16x16x32_bf16 v[44:47], v[72:75], v[100:103], v[44:47]
    ds_read_b128 v[168:171], v216 offset:2688
    v_mfma_f32_16x16x32_bf16 v[40:43], v[72:75], v[96:99], v[40:43]
    ds_read_b128 v[164:167], v216 offset:3200
    s_waitcnt lgkmcnt(15)
    v_mfma_f32_16x16x32_bf16 v[60:63], v[76:79], v[112:115], v[60:63]
    ds_read_b128 v[160:163], v216 offset:3712
    v_mfma_f32_16x16x32_bf16 v[56:59], v[76:79], v[108:111], v[56:59]
    ds_read2_b32 v[132:133], v212 offset0:160 offset1:161
    s_add_u32 s55, s56, 14336
    buffer_load_dwordx4 v14, s[12:15], s55 offen offset:2048 lds
    v_mfma_f32_16x16x32_bf16 v[52:55], v[76:79], v[104:107], v[52:55]
    ds_read2_b32 v[134:135], v212 offset0:162 offset1:163
    v_mfma_f32_16x16x32_bf16 v[48:51], v[76:79], v[100:103], v[48:51]
    ds_read2_b32 v[136:137], v213 offset0:32 offset1:33
    v_mfma_f32_16x16x32_bf16 v[44:47], v[76:79], v[96:99], v[44:47]
    ds_read2_b32 v[138:139], v213 offset0:34 offset1:35
    v_mfma_f32_16x16x32_bf16 v[60:63], v[80:83], v[108:111], v[60:63]
    ds_read2_b32 v[140:141], v213 offset0:160 offset1:161
    v_mfma_f32_16x16x32_bf16 v[56:59], v[80:83], v[104:107], v[56:59]
    ds_read2_b32 v[142:143], v213 offset0:162 offset1:163
    v_mfma_f32_16x16x32_bf16 v[52:55], v[80:83], v[100:103], v[52:55]
    ds_read2_b32 v[144:145], v214 offset0:32 offset1:33
    v_mfma_f32_16x16x32_bf16 v[48:51], v[80:83], v[96:99], v[48:51]
    ds_read2_b32 v[146:147], v214 offset0:34 offset1:35
    s_waitcnt lgkmcnt(15)
    v_mfma_f32_16x16x32_bf16 v[60:63], v[84:87], v[104:107], v[60:63]
    ds_read2_b32 v[148:149], v214 offset0:160 offset1:161
    v_mfma_f32_16x16x32_bf16 v[56:59], v[84:87], v[100:103], v[56:59]
    ds_read2_b32 v[150:151], v214 offset0:162 offset1:163
    s_add_u32 s55, s56, 21504
    buffer_load_dwordx4 v14, s[12:15], s55 offen offset:3072 lds
    v_mfma_f32_16x16x32_bf16 v[52:55], v[84:87], v[96:99], v[52:55]
    ds_read2_b32 v[152:153], v215 offset0:32 offset1:33
    v_mfma_f32_16x16x32_bf16 v[60:63], v[88:91], v[100:103], v[60:63]
    ds_read2_b32 v[154:155], v215 offset0:34 offset1:35
    v_mfma_f32_16x16x32_bf16 v[56:59], v[88:91], v[96:99], v[56:59]
    ds_read2_b32 v[156:157], v215 offset0:160 offset1:161
    v_mfma_f32_16x16x32_bf16 v[60:63], v[92:95], v[96:99], v[60:63]
    ds_read2_b32 v[158:159], v215 offset0:162 offset1:163
    v_mfma_f32_16x16x32_bf16 v[60:63], v[128:131], v[188:191], v[60:63]
    ds_read2_b32 v[64:65], v212 offset0:64 offset1:65
    s_waitcnt lgkmcnt(1)
    v_mfma_f32_16x16x32_bf16 v[56:59], v[128:131], v[184:187], v[56:59]
    ds_read2_b32 v[66:67], v212 offset0:66 offset1:67
    v_mfma_f32_16x16x32_bf16 v[52:55], v[128:131], v[180:183], v[52:55]
    ds_read_b128 v[124:127], v216 offset:256
    v_mfma_f32_16x16x32_bf16 v[48:51], v[128:131], v[176:179], v[48:51]
    ds_read_b128 v[120:123], v216 offset:768
    v_mfma_f32_16x16x32_bf16 v[44:47], v[128:131], v[172:175], v[44:47]
    ds_read_b128 v[116:119], v216 offset:1280
    s_add_u32 m0, s57, 4096
    s_add_u32 s55, s56, 32768
    buffer_load_dwordx4 v14, s[12:15], s55 offen offset:0 lds
    v_mfma_f32_16x16x32_bf16 v[40:43], v[128:131], v[168:171], v[40:43]
    ds_read_b128 v[112:115], v216 offset:1792
    v_mfma_f32_16x16x32_bf16 v[36:39], v[128:131], v[164:167], v[36:39]
    ds_read_b128 v[108:111], v216 offset:2304
    v_mfma_f32_16x16x32_bf16 v[32:35], v[128:131], v[160:163], v[32:35]
    ds_read_b128 v[104:107], v216 offset:2816
    v_mfma_f32_16x16x32_bf16 v[60:63], v[132:135], v[184:187], v[60:63]
    ds_read_b128 v[100:103], v216 offset:3328
    v_mfma_f32_16x16x32_bf16 v[56:59], v[132:135], v[180:183], v[56:59]
    ds_read_b128 v[96:99], v216 offset:3840
    v_mfma_f32_16x16x32_bf16 v[52:55], v[132:135], v[176:179], v[52:55]
    ds_read2_b32 v[68:69], v212 offset0:192 offset1:193
    v_mfma_f32_16x16x32_bf16 v[48:51], v[132:135], v[172:175], v[48:51]
    ds_read2_b32 v[70:71], v212 offset0:194 offset1:195
    v_mfma_f32_16x16x32_bf16 v[44:47], v[132:135], v[168:171], v[44:47]
    ds_read2_b32 v[72:73], v213 offset0:64 offset1:65
    v_mfma_f32_16x16x32_bf16 v[40:43], v[132:135], v[164:167], v[40:43]
    ds_read2_b32 v[74:75], v213 offset0:66 offset1:67
    s_add_u32 s55, s56, 39936
    buffer_load_dwordx4 v14, s[12:15], s55 offen offset:1024 lds
    v_mfma_f32_16x16x32_bf16 v[36:39], v[132:135], v[160:163], v[36:39]
    ds_read2_b32 v[76:77], v213 offset0:192 offset1:193
    v_mfma_f32_16x16x32_bf16 v[60:63], v[136:139], v[180:183], v[60:63]
    ds_read2_b32 v[78:79], v213 offset0:194 offset1:195
    v_mfma_f32_16x16x32_bf16 v[56:59], v[136:139], v[176:179], v[56:59]
    ds_read2_b32 v[80:81], v214 offset0:64 offset1:65
    v_mfma_f32_16x16x32_bf16 v[52:55], v[136:139], v[172:175], v[52:55]
    ds_read2_b32 v[82:83], v214 offset0:66 offset1:67
    v_mfma_f32_16x16x32_bf16 v[48:51], v[136:139], v[168:171], v[48:51]
    ds_read2_b32 v[84:85], v214 offset0:192 offset1:193
    v_mfma_f32_16x16x32_bf16 v[44:47], v[136:139], v[164:167], v[44:47]
    ds_read2_b32 v[86:87], v214 offset0:194 offset1:195
    v_mfma_f32_16x16x32_bf16 v[40:43], v[136:139], v[160:163], v[40:43]
    ds_read2_b32 v[88:89], v215 offset0:64 offset1:65
    v_mfma_f32_16x16x32_bf16 v[60:63], v[140:143], v[176:179], v[60:63]
    ds_read2_b32 v[90:91], v215 offset0:66 offset1:67
    v_mfma_f32_16x16x32_bf16 v[56:59], v[140:143], v[172:175], v[56:59]
    ds_read2_b32 v[92:93], v215 offset0:192 offset1:193
    s_add_u32 s55, s56, 47104
    buffer_load_dwordx4 v14, s[12:15], s55 offen offset:2048 lds
    v_mfma_f32_16x16x32_bf16 v[52:55], v[140:143], v[168:171], v[52:55]
    ds_read2_b32 v[94:95], v215 offset0:194 offset1:195
    v_mfma_f32_16x16x32_bf16 v[48:51], v[140:143], v[164:167], v[48:51]
    v_mfma_f32_16x16x32_bf16 v[44:47], v[140:143], v[160:163], v[44:47]
    v_mfma_f32_16x16x32_bf16 v[60:63], v[144:147], v[172:175], v[60:63]
    v_mfma_f32_16x16x32_bf16 v[56:59], v[144:147], v[168:171], v[56:59]
    v_mfma_f32_16x16x32_bf16 v[52:55], v[144:147], v[164:167], v[52:55]
    v_mfma_f32_16x16x32_bf16 v[48:51], v[144:147], v[160:163], v[48:51]
    v_mfma_f32_16x16x32_bf16 v[60:63], v[148:151], v[168:171], v[60:63]
    v_mfma_f32_16x16x32_bf16 v[56:59], v[148:151], v[164:167], v[56:59]
    s_add_u32 s55, s56, 54272
    buffer_load_dwordx4 v14, s[12:15], s55 offen offset:3072 lds
    v_mfma_f32_16x16x32_bf16 v[52:55], v[148:151], v[160:163], v[52:55]
    v_mfma_f32_16x16x32_bf16 v[60:63], v[152:155], v[164:167], v[60:63]
    v_mfma_f32_16x16x32_bf16 v[56:59], v[152:155], v[160:163], v[56:59]
    v_mfma_f32_16x16x32_bf16 v[60:63], v[156:159], v[160:163], v[60:63]
    s_waitcnt lgkmcnt(0)
    v_mfma_f32_16x16x32_bf16 v[60:63], v[64:67], v[124:127], v[60:63]
    ds_read2_b32 v[128:129], v212 offset0:96 offset1:97
    v_mfma_f32_16x16x32_bf16 v[56:59], v[64:67], v[120:123], v[56:59]
    ds_read2_b32 v[130:131], v212 offset0:98 offset1:99
    v_mfma_f32_16x16x32_bf16 v[52:55], v[64:67], v[116:119], v[52:55]
    ds_read_b128 v[188:191], v216 offset:384
    v_mfma_f32_16x16x32_bf16 v[48:51], v[64:67], v[112:115], v[48:51]
    ds_read_b128 v[184:187], v216 offset:896
    v_mfma_f32_16x16x32_bf16 v[44:47], v[64:67], v[108:111], v[44:47]
    ds_read_b128 v[180:183], v216 offset:1408
    s_add_u32 m0, s57, 8192
    s_add_u32 s55, s56, 65536
    buffer_load_dwordx4 v14, s[12:15], s55 offen offset:0 lds
    v_mfma_f32_16x16x32_bf16 v[40:43], v[64:67], v[104:107], v[40:43]
    ds_read_b128 v[176:179], v216 offset:1920
    v_mfma_f32_16x16x32_bf16 v[36:39], v[64:67], v[100:103], v[36:39]
    ds_read_b128 v[172:175], v216 offset:2432
    v_mfma_f32_16x16x32_bf16 v[32:35], v[64:67], v[96:99], v[32:35]
    ds_read_b128 v[168:171], v216 offset:2944
    v_mfma_f32_16x16x32_bf16 v[60:63], v[68:71], v[120:123], v[60:63]
    ds_read_b128 v[164:167], v216 offset:3456
    v_mfma_f32_16x16x32_bf16 v[56:59], v[68:71], v[116:119], v[56:59]
    ds_read_b128 v[160:163], v216 offset:3968
    v_mfma_f32_16x16x32_bf16 v[52:55], v[68:71], v[112:115], v[52:55]
    ds_read2_b32 v[132:133], v212 offset0:224 offset1:225
    v_mfma_f32_16x16x32_bf16 v[48:51], v[68:71], v[108:111], v[48:51]
    ds_read2_b32 v[134:135], v212 offset0:226 offset1:227
    v_mfma_f32_16x16x32_bf16 v[44:47], v[68:71], v[104:107], v[44:47]
    ds_read2_b32 v[136:137], v213 offset0:96 offset1:97
    v_mfma_f32_16x16x32_bf16 v[40:43], v[68:71], v[100:103], v[40:43]
    ds_read2_b32 v[138:139], v213 offset0:98 offset1:99
    s_add_u32 s55, s56, 72704
    buffer_load_dwordx4 v14, s[12:15], s55 offen offset:1024 lds
    v_mfma_f32_16x16x32_bf16 v[36:39], v[68:71], v[96:99], v[36:39]
    ds_read2_b32 v[140:141], v213 offset0:224 offset1:225
    v_mfma_f32_16x16x32_bf16 v[60:63], v[72:75], v[116:119], v[60:63]
    ds_read2_b32 v[142:143], v213 offset0:226 offset1:227
    v_mfma_f32_16x16x32_bf16 v[56:59], v[72:75], v[112:115], v[56:59]
    ds_read2_b32 v[144:145], v214 offset0:96 offset1:97
    v_mfma_f32_16x16x32_bf16 v[52:55], v[72:75], v[108:111], v[52:55]
    ds_read2_b32 v[146:147], v214 offset0:98 offset1:99
    v_mfma_f32_16x16x32_bf16 v[48:51], v[72:75], v[104:107], v[48:51]
    ds_read2_b32 v[148:149], v214 offset0:224 offset1:225
    v_mfma_f32_16x16x32_bf16 v[44:47], v[72:75], v[100:103], v[44:47]
    ds_read2_b32 v[150:151], v214 offset0:226 offset1:227
    v_mfma_f32_16x16x32_bf16 v[40:43], v[72:75], v[96:99], v[40:43]
    ds_read2_b32 v[152:153], v215 offset0:96 offset1:97
    v_mfma_f32_16x16x32_bf16 v[60:63], v[76:79], v[112:115], v[60:63]
    ds_read2_b32 v[154:155], v215 offset0:98 offset1:99
    v_mfma_f32_16x16x32_bf16 v[56:59], v[76:79], v[108:111], v[56:59]
    ds_read2_b32 v[156:157], v215 offset0:224 offset1:225
    s_add_u32 s55, s56, 79872
    buffer_load_dwordx4 v14, s[12:15], s55 offen offset:2048 lds
    v_mfma_f32_16x16x32_bf16 v[52:55], v[76:79], v[104:107], v[52:55]
    ds_read2_b32 v[158:159], v215 offset0:226 offset1:227
    v_mfma_f32_16x16x32_bf16 v[48:51], v[76:79], v[100:103], v[48:51]
    v_mfma_f32_16x16x32_bf16 v[44:47], v[76:79], v[96:99], v[44:47]
    v_mfma_f32_16x16x32_bf16 v[60:63], v[80:83], v[108:111], v[60:63]
    v_mfma_f32_16x16x32_bf16 v[56:59], v[80:83], v[104:107], v[56:59]
    v_mfma_f32_16x16x32_bf16 v[52:55], v[80:83], v[100:103], v[52:55]
    v_mfma_f32_16x16x32_bf16 v[48:51], v[80:83], v[96:99], v[48:51]
    v_mfma_f32_16x16x32_bf16 v[60:63], v[84:87], v[104:107], v[60:63]
    v_mfma_f32_16x16x32_bf16 v[56:59], v[84:87], v[100:103], v[56:59]
L_st4000:
    s_cbranch_execz L_tyr
    s_add_u32 s55, s56, 87040
    buffer_load_dwordx4 v14, s[12:15], s55 offen offset:3072 lds
    v_mfma_f32_16x16x32_bf16 v[52:55], v[84:87], v[96:99], v[52:55]
    v_mfma_f32_16x16x32_bf16 v[60:63], v[88:91], v[100:103], v[60:63]
    v_mfma_f32_16x16x32_bf16 v[56:59], v[88:91], v[96:99], v[56:59]
    v_mfma_f32_16x16x32_bf16 v[60:63], v[92:95], v[96:99], v[60:63]
    s_waitcnt lgkmcnt(0)
    v_mfma_f32_16x16x32_bf16 v[60:63], v[128:131], v[188:191], v[60:63]
    v_mfma_f32_16x16x32_bf16 v[56:59], v[128:131], v[184:187], v[56:59]
    v_mfma_f32_16x16x32_bf16 v[52:55], v[128:131], v[180:183], v[52:55]
    v_mfma_f32_16x16x32_bf16 v[48:51], v[128:131], v[176:179], v[48:51]
    v_mfma_f32_16x16x32_bf16 v[44:47], v[128:131], v[172:175], v[44:47]
    s_add_u32 m0, s57, 12288
    s_add_u32 s55, s56, 98304
    buffer_load_dwordx4 v14, s[12:15], s55 offen offset:0 lds
    v_mfma_f32_16x16x32_bf16 v[40:43], v[128:131], v[168:171], v[40:43]
    v_mfma_f32_16x16x32_bf16 v[36:39], v[128:131], v[164:167], v[36:39]
    v_mfma_f32_16x16x32_bf16 v[32:35], v[128:131], v[160:163], v[32:35]
    v_mfma_f32_16x16x32_bf16 v[60:63], v[132:135], v[184:187], v[60:63]
    v_mfma_f32_16x16x32_bf16 v[56:59], v[132:135], v[180:183], v[56:59]
    v_mfma_f32_16x16x32_bf16 v[52:55], v[132:135], v[176:179], v[52:55]
    v_mfma_f32_16x16x32_bf16 v[48:51], v[132:135], v[172:175], v[48:51]
    v_mfma_f32_16x16x32_bf16 v[44:47], v[132:135], v[168:171], v[44:47]
    v_mfma_f32_16x16x32_bf16 v[40:43], v[132:135], v[164:167], v[40:43]
    s_add_u32 s55, s56, 105472
    buffer_load_dwordx4 v14, s[12:15], s55 offen offset:1024 lds
    v_mfma_f32_16x16x32_bf16 v[36:39], v[132:135], v[160:163], v[36:39]
    v_mfma_f32_16x16x32_bf16 v[60:63], v[136:139], v[180:183], v[60:63]
    v_mfma_f32_16x16x32_bf16 v[56:59], v[136:139], v[176:179], v[56:59]
    v_mfma_f32_16x16x32_bf16 v[52:55], v[136:139], v[172:175], v[52:55]
    v_mfma_f32_16x16x32_bf16 v[48:51], v[136:139], v[168:171], v[48:51]
    v_mfma_f32_16x16x32_bf16 v[44:47], v[136:139], v[164:167], v[44:47]
    v_mfma_f32_16x16x32_bf16 v[40:43], v[136:139], v[160:163], v[40:43]
    v_mfma_f32_16x16x32_bf16 v[60:63], v[140:143], v[176:179], v[60:63]
    v_mfma_f32_16x16x32_bf16 v[56:59], v[140:143], v[172:175], v[56:59]
    s_add_u32 s55, s56, 112640
    buffer_load_dwordx4 v14, s[12:15], s55 offen offset:2048 lds
    v_mfma_f32_16x16x32_bf16 v[52:55], v[140:143], v[168:171], v[52:55]
    v_mfma_f32_16x16x32_bf16 v[48:51], v[140:143], v[164:167], v[48:51]
    v_mfma_f32_16x16x32_bf16 v[44:47], v[140:143], v[160:163], v[44:47]
    v_mfma_f32_16x16x32_bf16 v[60:63], v[144:147], v[172:175], v[60:63]
    v_mfma_f32_16x16x32_bf16 v[56:59], v[144:147], v[168:171], v[56:59]
    v_mfma_f32_16x16x32_bf16 v[52:55], v[144:147], v[164:167], v[52:55]
    v_mfma_f32_16x16x32_bf16 v[48:51], v[144:147], v[160:163], v[48:51]
    v_mfma_f32_16x16x32_bf16 v[60:63], v[148:151], v[168:171], v[60:63]
    v_mfma_f32_16x16x32_bf16 v[56:59], v[148:151], v[164:167], v[56:59]
    s_add_u32 s55, s56, 119808
    buffer_load_dwordx4 v14, s[12:15], s55 offen offset:3072 lds
    v_mfma_f32_16x16x32_bf16 v[52:55], v[148:151], v[160:163], v[52:55]
    v_mfma_f32_16x16x32_bf16 v[60:63], v[152:155], v[164:167], v[60:63]
    v_mfma_f32_16x16x32_bf16 v[56:59], v[152:155], v[160:163], v[56:59]
    v_mfma_f32_16x16x32_bf16 v[60:63], v[156:159], v[160:163], v[60:63]
    s_mov_b64 s[64:65], s[40:41]
    s_mov_b32 s66, 0x400000
    s_mov_b32 s67, 0x00020000
    s_add_u32 s74, s74, 0x600000
    v_mov_b32 v16, v221
    v_mov_b32 v17, v222
    s_nop 2
    s_setprio 3
    ds_write_b128 v217, v[32:35] offset:0
    ds_write_b128 v217, v[36:39] offset:1024
    ds_write_b128 v217, v[40:43] offset:2048
    ds_write_b128 v217, v[44:47] offset:3072
    ds_write_b128 v217, v[48:51] offset:4096
    ds_write_b128 v217, v[52:55] offset:5120
    ds_write_b128 v217, v[56:59] offset:6144
    ds_write_b128 v217, v[60:63] offset:7168
    s_waitcnt vmcnt(0)
    s_lshl1_add_u32 s57, s49, s52
    s_lshl4_add_u32 s57, s57, s50
    s_lshl1_add_u32 s57, s57, s53
    s_lshl_b32 s57, s57, 10
    s_add_u32 s55, s57, 0x200000
    buffer_store_dwordx4 v[24:27], v5, s[4:7], s55 offen sc1
    s_add_u32 s55, s57, 0x204000
    buffer_store_dwordx4 v[24:27], v5, s[4:7], s55 offen sc1
    s_add_u32 s55, s57, 0xa00000
    buffer_store_dwordx4 v[24:27], v5, s[4:7], s55 offen sc1
    s_add_u32 s55, s57, 0xa04000
    buffer_store_dwordx4 v[24:27], v5, s[4:7], s55 offen sc1
    s_waitcnt lgkmcnt(0)
    s_mov_b64 exec, 1
    ds_add_u32 v4, v3 offset:4
    s_mov_b64 exec, -1
L_lw_10:
    ds_read_b32 v7, v4 offset:4
    s_waitcnt lgkmcnt(0)
    v_readfirstlane_b32 s59, v7
    s_cmp_ge_u32 s59, 16
    s_cbranch_scc1 L_lwd_11
    s_sleep 1
    s_branch L_lw_10
L_lwd_11:
    ds_read_b128 v[64:67], v218 offset:0
    ds_read_b128 v[68:71], v218 offset:1024
    ds_read_b128 v[72:75], v218 offset:8192
    ds_read_b128 v[76:79], v218 offset:9216
    ds_read_b128 v[80:83], v218 offset:16384
    ds_read_b128 v[84:87], v218 offset:17408
    ds_read_b128 v[88:91], v218 offset:24576
    ds_read_b128 v[92:95], v218 offset:25600
    s_waitcnt lgkmcnt(4)
    v_pk_add_f32 v[64:65], v[64:65], v[72:73]
    v_pk_add_f32 v[66:67], v[66:67], v[74:75]
    v_pk_add_f32 v[68:69], v[68:69], v[76:77]
    v_pk_add_f32 v[70:71], v[70:71], v[78:79]
    s_waitcnt lgkmcnt(0)
    v_pk_add_f32 v[80:81], v[80:81], v[88:89]
    v_pk_add_f32 v[82:83], v[82:83], v[90:91]
    v_pk_add_f32 v[84:85], v[84:85], v[92:93]
    v_pk_add_f32 v[86:87], v[86:87], v[94:95]
    v_cvt_pk_bf16_f32 v64, v64, v80
    v_cvt_pk_bf16_f32 v65, v65, v81
    v_cvt_pk_bf16_f32 v66, v66, v82
    v_cvt_pk_bf16_f32 v67, v67, v83
    v_cvt_pk_bf16_f32 v68, v68, v84
    v_cvt_pk_bf16_f32 v69, v69, v85
    v_cvt_pk_bf16_f32 v70, v70, v86
    v_cvt_pk_bf16_f32 v71, v71, v87
    buffer_store_dwordx4 v[64:67], v219, s[4:7], s74 offen offset:0 sc1
    buffer_store_dwordx4 v[68:71], v219, s[4:7], s74 offen offset:1024 sc1
    s_lshl1_add_u32 s72, s49, s52
    s_lshl2_add_u32 s72, s72, s53
    s_lshl_b32 s72, s72, 13
    s_add_u32 s72, s72, 0x200000
    s_lshl_b32 s73, s53, 15
    s_add_u32 s73, s73, 65536
    s_add_u32 s58, s50, 1
    s_and_b32 s58, s58, 3
    s_lshl_b32 s58, s58, 11
    s_add_u32 s68, s72, s58
    s_lshl2_add_u32 s58, s58, s73
    v_add_u32 v13, s58, v6
    v_xor_b32 v15, 64, v13
    s_waitcnt lgkmcnt(4)
    ds_read_b64_tr_b16 v[128:129], v13 offset:0
    ds_read_b64_tr_b16 v[130:131], v13 offset:1024
    ds_read_b64_tr_b16 v[132:133], v15 offset:0
    ds_read_b64_tr_b16 v[134:135], v15 offset:1024
    ds_read_b64_tr_b16 v[136:137], v13 offset:2048
    ds_read_b64_tr_b16 v[138:139], v13 offset:3072
    ds_read_b64_tr_b16 v[140:141], v15 offset:2048
    ds_read_b64_tr_b16 v[142:143], v15 offset:3072
    s_waitcnt lgkmcnt(4)
    ds_read_b64_tr_b16 v[144:145], v13 offset:4096
    ds_read_b64_tr_b16 v[146:147], v13 offset:5120
    ds_read_b64_tr_b16 v[148:149], v15 offset:4096
    ds_read_b64_tr_b16 v[150:151], v15 offset:5120
    ds_read_b64_tr_b16 v[152:153], v13 offset:6144
    ds_read_b64_tr_b16 v[154:155], v13 offset:7168
    ds_read_b64_tr_b16 v[156:157], v15 offset:6144
    ds_read_b64_tr_b16 v[158:159], v15 offset:7168
    s_add_u32 s58, s50, 2
    s_and_b32 s58, s58, 3
    s_lshl_b32 s58, s58, 11
    s_add_u32 s69, s72, s58
    s_lshl2_add_u32 s58, s58, s73
    v_add_u32 v13, s58, v6
    v_xor_b32 v15, 64, v13
    s_waitcnt lgkmcnt(4)
    ds_read_b64_tr_b16 v[160:161], v13 offset:0
    ds_read_b64_tr_b16 v[162:163], v13 offset:1024
    ds_read_b64_tr_b16 v[164:165], v15 offset:0
    ds_read_b64_tr_b16 v[166:167], v15 offset:1024
    ds_read_b64_tr_b16 v[168:169], v13 offset:2048
    ds_read_b64_tr_b16 v[170:171], v13 offset:3072
    ds_read_b64_tr_b16 v[172:173], v15 offset:2048
    ds_read_b64_tr_b16 v[174:175], v15 offset:3072
    s_waitcnt lgkmcnt(4)
    ds_read_b64_tr_b16 v[176:177], v13 offset:4096
    ds_read_b64_tr_b16 v[178:179], v13 offset:5120
    ds_read_b64_tr_b16 v[180:181], v15 offset:4096
    ds_read_b64_tr_b16 v[182:183], v15 offset:5120
    ds_read_b64_tr_b16 v[184:185], v13 offset:6144
    ds_read_b64_tr_b16 v[186:187], v13 offset:7168
    ds_read_b64_tr_b16 v[188:189], v15 offset:6144
    ds_read_b64_tr_b16 v[190:191], v15 offset:7168
    s_add_u32 s58, s50, 3
    s_and_b32 s58, s58, 3
    s_lshl_b32 s58, s58, 11
    s_add_u32 s70, s72, s58
    s_lshl2_add_u32 s58, s58, s73
    v_add_u32 v13, s58, v6
    v_xor_b32 v15, 64, v13
    s_waitcnt lgkmcnt(4)
    ds_read_b64_tr_b16 v[192:193], v13 offset:0
    ds_read_b64_tr_b16 v[194:195], v13 offset:1024
    ds_read_b64_tr_b16 v[196:197], v15 offset:0
    ds_read_b64_tr_b16 v[198:199], v15 offset:1024
    ds_read_b64_tr_b16 v[200:201], v13 offset:2048
    ds_read_b64_tr_b16 v[202:203], v13 offset:3072
    ds_read_b64_tr_b16 v[204:205], v15 offset:2048
    ds_read_b64_tr_b16 v[206:207], v15 offset:3072
    s_waitcnt lgkmcnt(4)
    ds_read_b64_tr_b16 v[208:209], v13 offset:4096
    ds_read_b64_tr_b16 v[210:211], v13 offset:5120
    ds_read_b64_tr_b16 v[212:213], v15 offset:4096
    ds_read_b64_tr_b16 v[214:215], v15 offset:5120
    ds_read_b64_tr_b16 v[216:217], v13 offset:6144
    ds_read_b64_tr_b16 v[218:219], v13 offset:7168
    ds_read_b64_tr_b16 v[220:221], v15 offset:6144
    ds_read_b64_tr_b16 v[222:223], v15 offset:7168
    s_add_u32 s58, s50, 4
    s_and_b32 s58, s58, 3
    s_lshl_b32 s58, s58, 11
    s_add_u32 s71, s72, s58
    s_lshl2_add_u32 s58, s58, s73
    v_add_u32 v13, s58, v6
    v_xor_b32 v15, 64, v13
    s_waitcnt lgkmcnt(4)
    ds_read_b64_tr_b16 v[224:225], v13 offset:0
    ds_read_b64_tr_b16 v[226:227], v13 offset:1024
    ds_read_b64_tr_b16 v[228:229], v15 offset:0
    ds_read_b64_tr_b16 v[230:231], v15 offset:1024
    ds_read_b64_tr_b16 v[232:233], v13 offset:2048
    ds_read_b64_tr_b16 v[234:235], v13 offset:3072
    ds_read_b64_tr_b16 v[236:237], v15 offset:2048
    ds_read_b64_tr_b16 v[238:239], v15 offset:3072
    s_waitcnt lgkmcnt(4)
    ds_read_b64_tr_b16 v[240:241], v13 offset:4096
    ds_read_b64_tr_b16 v[242:243], v13 offset:5120
    ds_read_b64_tr_b16 v[244:245], v15 offset:4096
    ds_read_b64_tr_b16 v[246:247], v15 offset:5120
    ds_read_b64_tr_b16 v[248:249], v13 offset:6144
    ds_read_b64_tr_b16 v[250:251], v13 offset:7168
    ds_read_b64_tr_b16 v[252:253], v15 offset:6144
    ds_read_b64_tr_b16 v[254:255], v15 offset:7168
    s_lshl2_add_u32 s55, s48, s63
    s_lshl_b32 s55, s55, 6
    s_lshl_b32 s56, s47, 18
    s_add_u32 s55, s55, s56
    s_add_u32 s55, s55, 0x600000
    s_waitcnt vmcnt(0) lgkmcnt(0)
    s_mov_b64 exec, 1
    ds_add_u32 v4, v3 offset:4
    s_mov_b64 exec, -1
    s_cmp_lg_u32 s63, 0
    s_cbranch_scc1 L_gyw
L_lw_12:
    ds_read_b32 v7, v4 offset:4
    s_waitcnt lgkmcnt(0)
    v_readfirstlane_b32 s59, v7
    s_cmp_ge_u32 s59, 20
    s_cbranch_scc1 L_lwd_13
    s_sleep 1
    s_branch L_lw_12
L_lwd_13:
    s_lshl_b32 s54, s48, 7
    s_add_u32 s54, s54, s77
    s_mov_b64 exec, 1
    buffer_store_dwordx2 v[22:23], v1, s[4:7], s54 offen offset:8 sc1
    s_mov_b64 exec, -1
    s_mov_b32 s62, 65536
    s_sleep 8
L_gy:
    buffer_load_dwordx2 v[18:19], v17, s[4:7], s77 offen offset:8 sc1
    s_sub_u32 s62, s62, 1
    s_waitcnt vmcnt(0)
    s_cbranch_scc1 L_gyd
    v_cmp_ne_u64 vcc, v[22:23], v[18:19]
    s_cbranch_vccz L_gyd
    s_sleep 8
    s_branch L_gy
L_gyd:
    s_mov_b64 exec, 1
    ds_add_u32 v4, v3 offset:20
    s_mov_b64 exec, -1
    s_branch L_gye
L_gyw:
L_lw_14:
    ds_read_b32 v7, v4 offset:20
    s_waitcnt lgkmcnt(0)
    v_readfirstlane_b32 s59, v7
    s_cmp_ge_u32 s59, 2
    s_cbranch_scc1 L_lwd_15
    s_sleep 4
    s_branch L_lw_14
L_lwd_15:
L_gye:
    buffer_load_dwordx4 v[64:67], v16, s[4:7], s55 offen offset:0 sc1
    buffer_load_dwordx4 v[68:71], v16, s[4:7], s55 offen offset:32 sc1
    s_lshl2_add_u32 s54, s48, s63
    s_lshl_b32 s54, s54, 8
    s_add_u32 s54, s54, s47
    s_add_u32 s54, s54, 8
    s_lshl_b32 s54, s54, 7
    s_add_u32 s55, s54, 4096
    s_add_u32 s56, s54, 0x4000
    s_add_u32 s57, s54, 0x5000
    s_waitcnt vmcnt(1)
    buffer_store_dword v64, v12, s[64:67], s54 offen offset:0
    buffer_store_dword v65, v12, s[64:67], s54 offen offset:2048
    buffer_store_dword v66, v12, s[64:67], s55 offen offset:0
    buffer_store_dword v67, v12, s[64:67], s55 offen offset:2048
    s_waitcnt vmcnt(4)
    buffer_store_dword v68, v12, s[64:67], s56 offen offset:0
    buffer_store_dword v69, v12, s[64:67], s56 offen offset:2048
    buffer_store_dword v70, v12, s[64:67], s57 offen offset:0
    buffer_store_dword v71, v12, s[64:67], s57 offen offset:2048
    s_or_b32 s55, s2, s63
    s_cbranch_scc1 L_nb
    s_mov_b64 exec, 1
    s_mov_b32 s60, 0x47000
    buffer_load_dwordx2 v[28:29], v1, s[4:7], s60 offen sc1
    s_mov_b32 s61, 0xf0000
    buffer_load_dwordx2 v[30:31], v1, s[4:7], s61 offen sc1
    s_waitcnt vmcnt(0)
    s_mov_b32 s72, 0x7f4a7c15
    s_mov_b32 s73, 0x9e3779b9
    v_lshl_add_u64 v[28:29], v[28:29], 0, s[72:73]
    buffer_store_dwordx2 v[28:29], v1, s[4:7], s60 offen sc1
    s_mov_b32 s72, 0x27d4eb4f
    s_mov_b32 s73, 0xc2b2ae3d
    v_lshl_add_u64 v[30:31], v[30:31], 0, s[72:73]
    buffer_store_dwordx2 v[30:31], v1, s[4:7], s61 offen sc1
    s_mov_b64 exec, -1
L_nb:
    s_lshl1_add_u32 s54, s49, s52
    s_lshl_b32 s54, s54, 16
    s_lshl1_add_u32 s55, s50, s53
    s_lshl_b32 s55, s55, 6
    s_add_u32 s54, s54, s55
    s_waitcnt vmcnt(0) lgkmcnt(0)
    s_setprio 0
    v_add_u32 v8, 0x4000, v5
    buffer_load_dwordx4 v[68:71], v8, s[4:7], s68 offen offset:0 sc1
    buffer_load_dwordx4 v[76:79], v8, s[4:7], s68 offen offset:1024 sc1
    buffer_load_dwordx4 v[84:87], v8, s[4:7], s69 offen offset:0 sc1
    buffer_load_dwordx4 v[92:95], v8, s[4:7], s69 offen offset:1024 sc1
    buffer_load_dwordx4 v[100:103], v8, s[4:7], s70 offen offset:0 sc1
    buffer_load_dwordx4 v[108:111], v8, s[4:7], s70 offen offset:1024 sc1
    buffer_load_dwordx4 v[116:119], v8, s[4:7], s71 offen offset:0 sc1
    buffer_load_dwordx4 v[124:127], v8, s[4:7], s71 offen offset:1024 sc1
    s_mov_b64 s[32:33], -1
    s_movk_i32 s55, 15
    s_movk_i32 s62, 400
    s_movk_i32 s58, 3
    s_mov_b64 exec, 0
    s_branch L_s20
L_t2r:
    s_mov_b64 exec, -1
    s_barrier
    s_barrier
    buffer_load_dwordx4 v[64:67], v5, s[4:7], s68 offen offset:0 sc1
    buffer_load_dwordx4 v[72:75], v5, s[4:7], s68 offen offset:1024 sc1
    buffer_load_dwordx4 v[80:83], v5, s[4:7], s69 offen offset:0 sc1
    buffer_load_dwordx4 v[88:91], v5, s[4:7], s69 offen offset:1024 sc1
    buffer_load_dwordx4 v[96:99], v5, s[4:7], s70 offen offset:0 sc1
    buffer_load_dwordx4 v[104:107], v5, s[4:7], s70 offen offset:1024 sc1
    buffer_load_dwordx4 v[112:115], v5, s[4:7], s71 offen offset:0 sc1
    buffer_load_dwordx4 v[120:123], v5, s[4:7], s71 offen offset:1024 sc1
    s_barrier
L_a:
    s_waitcnt vmcnt(0)
    v_cmp_u_f32 s[16:17], v67, v75
    v_cmp_u_f32 s[18:19], v83, v91
    v_cmp_u_f32 s[20:21], v99, v107
    v_cmp_u_f32 s[22:23], v115, v123
    s_or_b64 vcc, s[16:17], s[18:19]
    s_or_b64 vcc, vcc, s[20:21]
    s_or_b64 vcc, vcc, s[22:23]
    s_cbranch_scc1 L_ar
    buffer_load_dwordx4 v[68:71], v8, s[4:7], s68 offen offset:0 sc1
    buffer_load_dwordx4 v[76:79], v8, s[4:7], s68 offen offset:1024 sc1
    v_mfma_f32_32x32x16_bf16 v[48:63], v[132:135], v[64:67], 0
    v_mfma_f32_32x32x16_bf16 v[32:47], v[128:131], v[64:67], 0
    buffer_load_dwordx4 v[84:87], v8, s[4:7], s69 offen offset:0 sc1
    buffer_load_dwordx4 v[92:95], v8, s[4:7], s69 offen offset:1024 sc1
    v_mfma_f32_32x32x16_bf16 v[48:63], v[148:151], v[72:75], v[48:63]
    v_mfma_f32_32x32x16_bf16 v[32:47], v[144:147], v[72:75], v[32:47]
    buffer_load_dwordx4 v[100:103], v8, s[4:7], s70 offen offset:0 sc1
    buffer_load_dwordx4 v[108:111], v8, s[4:7], s70 offen offset:1024 sc1
    v_mfma_f32_32x32x16_bf16 v[48:63], v[164:167], v[80:83], v[48:63]
    v_mfma_f32_32x32x16_bf16 v[32:47], v[160:163], v[80:83], v[32:47]
    v_mfma_f32_32x32x16_bf16 v[48:63], v[180:183], v[88:91], v[48:63]
    v_mfma_f32_32x32x16_bf16 v[32:47], v[176:179], v[88:91], v[32:47]
    v_mfma_f32_32x32x16_bf16 v[48:63], v[196:199], v[96:99], v[48:63]
    v_mfma_f32_32x32x16_bf16 v[32:47], v[192:195], v[96:99], v[32:47]
    buffer_load_dwordx4 v[116:119], v8, s[4:7], s71 offen offset:0 sc1
    buffer_load_dwordx4 v[124:127], v8, s[4:7], s71 offen offset:1024 sc1
    v_mfma_f32_32x32x16_bf16 v[48:63], v[212:215], v[104:107], v[48:63]
    v_mfma_f32_32x32x16_bf16 v[32:47], v[208:211], v[104:107], v[32:47]
    v_mfma_f32_32x32x16_bf16 v[48:63], v[228:231], v[112:115], v[48:63]
    v_mfma_f32_32x32x16_bf16 v[32:47], v[224:227], v[112:115], v[32:47]
    v_mfma_f32_32x32x16_bf16 v[48:63], v[244:247], v[120:123], v[48:63]
    v_mfma_f32_32x32x16_bf16 v[32:47], v[240:243], v[120:123], v[32:47]
    s_waitcnt vmcnt(6)
L_o:
    v_cmp_u_f32 s[16:17], v71, v79
    v_cmp_u_f32 s[18:19], v87, v95
    v_cmp_u_f32 s[20:21], v103, v111
    v_cmp_u_f32 s[22:23], v119, v127
    s_lshl_b32 s57, -2, s58
    s_cmp_lg_u64 s[22:23], 0
    s_cselect_b32 s56, 1, 0
    s_cmp_lg_u64 s[20:21], 0
    s_addc_u32 s56, s56, s56
    s_cmp_lg_u64 s[18:19], 0
    s_addc_u32 s56, s56, s56
    s_cmp_lg_u64 s[16:17], 0
    s_addc_u32 s56, s56, s56
    s_andn2_b32 s24, s55, s56
    s_and_b32 s57, s57, s56
    s_cselect_b32 s57, s57, s56
    s_ff1_i32_b32 s58, s57
    s_cmp_eq_u32 s58, 0
    s_cbranch_scc1 L_p0x
    s_cmp_eq_u32 s58, 1
    s_cbranch_scc1 L_p1x
    s_cmp_eq_u32 s58, 2
    s_cbranch_scc1 L_p2x
    s_cmp_eq_u32 s58, 3
    s_cbranch_scc1 L_p3x
L_d:
    s_bitcmp1_b32 s24, 0
    s_cbranch_scc1 L_w0
    s_bitcmp1_b32 s24, 1
    s_cbranch_scc1 L_w1
    s_bitcmp1_b32 s24, 2
    s_cbranch_scc1 L_w2
    s_bitcmp1_b32 s24, 3
    s_cbranch_scc1 L_w3
    s_sub_u32 s62, s62, 1
    s_waitcnt vmcnt(12)
    s_cbranch_scc0 L_o
    s_branch L_ox
L_p0x:
    buffer_load_dwordx4 v[68:71], v8, s[4:7], s68 offen offset:0 sc1
    buffer_load_dwordx4 v[76:79], v8, s[4:7], s68 offen offset:1024 sc1
    s_branch L_d
L_s20:
    s_cbranch_execz L_s21
L_p1x:
    buffer_load_dwordx4 v[84:87], v8, s[4:7], s69 offen offset:0 sc1
    buffer_load_dwordx4 v[92:95], v8, s[4:7], s69 offen offset:1024 sc1
    s_branch L_d
L_s21:
    s_cbranch_execz L_s22
L_p2x:
    buffer_load_dwordx4 v[100:103], v8, s[4:7], s70 offen offset:0 sc1
    buffer_load_dwordx4 v[108:111], v8, s[4:7], s70 offen offset:1024 sc1
    s_branch L_d
L_s22:
    s_cbranch_execz L_s23
L_p3x:
    buffer_load_dwordx4 v[116:119], v8, s[4:7], s71 offen offset:0 sc1
    buffer_load_dwordx4 v[124:127], v8, s[4:7], s71 offen offset:1024 sc1
    s_branch L_d
L_s23:
    s_cbranch_execz L_s24
L_ar:
    s_sub_u32 s62, s62, 1
    s_cbranch_scc1 L_ox
    s_cmp_eq_u64 s[16:17], 0
    s_cbranch_scc1 L_ar0
    buffer_load_dwordx4 v[64:67], v5, s[4:7], s68 offen offset:0 sc1
    buffer_load_dwordx4 v[72:75], v5, s[4:7], s68 offen offset:1024 sc1
L_ar0:
    s_cmp_eq_u64 s[18:19], 0
    s_cbranch_scc1 L_ar1
    buffer_load_dwordx4 v[80:83], v5, s[4:7], s69 offen offset:0 sc1
    buffer_load_dwordx4 v[88:91], v5, s[4:7], s69 offen offset:1024 sc1
L_ar1:
    s_cmp_eq_u64 s[20:21], 0
    s_cbranch_scc1 L_ar2
    buffer_load_dwordx4 v[96:99], v5, s[4:7], s70 offen offset:0 sc1
    buffer_load_dwordx4 v[104:107], v5, s[4:7], s70 offen offset:1024 sc1
L_ar2:
    s_cmp_eq_u64 s[22:23], 0
    s_cbranch_scc1 L_ar3
    buffer_load_dwordx4 v[112:115], v5, s[4:7], s71 offen offset:0 sc1
    buffer_load_dwordx4 v[120:123], v5, s[4:7], s71 offen offset:1024 sc1
L_ar3:
    s_branch L_a
L_s24:
    s_cbranch_execz L_s25
L_w0:
    v_mfma_f32_32x32x16_bf16 v[48:63], v[140:143], v[68:71], v[48:63]
    s_cmp_lg_u32 s56, 0
    s_cselect_b32 s24, 0, s24
    v_mfma_f32_32x32x16_bf16 v[32:47], v[136:139], v[68:71], v[32:47]
    s_andn2_b32 s55, s55, 1
    v_mfma_f32_32x32x16_bf16 v[48:63], v[156:159], v[76:79], v[48:63]
    v_mfma_f32_32x32x16_bf16 v[32:47], v[152:155], v[76:79], v[32:47]
    s_cbranch_scc0 L_od
    s_bitcmp0_b32 s24, 1
    s_cbranch_scc1 L_o
L_w1:
    v_mfma_f32_32x32x16_bf16 v[48:63], v[172:175], v[84:87], v[48:63]
    s_cmp_lg_u32 s56, 0
    s_cselect_b32 s24, 0, s24
    v_mfma_f32_32x32x16_bf16 v[32:47], v[168:171], v[84:87], v[32:47]
    s_andn2_b32 s55, s55, 2
    v_mfma_f32_32x32x16_bf16 v[48:63], v[188:191], v[92:95], v[48:63]
    v_mfma_f32_32x32x16_bf16 v[32:47], v[184:187], v[92:95], v[32:47]
    s_cbranch_scc0 L_od
    s_bitcmp0_b32 s24, 2
    s_cbranch_scc1 L_o
L_w2:
    v_mfma_f32_32x32x16_bf16 v[48:63], v[204:207], v[100:103], v[48:63]
    s_cmp_lg_u32 s56, 0
    s_cselect_b32 s24, 0, s24
    v_mfma_f32_32x32x16_bf16 v[32:47], v[200:203], v[100:103], v[32:47]
L_s25:
    s_cbranch_execz L_s26
    s_andn2_b32 s55, s55, 4
    v_mfma_f32_32x32x16_bf16 v[48:63], v[220:223], v[108:111], v[48:63]
    v_mfma_f32_32x32x16_bf16 v[32:47], v[216:219], v[108:111], v[32:47]
    s_cbranch_scc0 L_od
    s_bitcmp0_b32 s24, 3
    s_cbranch_scc1 L_o
L_w3:
    v_mfma_f32_32x32x16_bf16 v[48:63], v[236:239], v[116:119], v[48:63]
    v_mfma_f32_32x32x16_bf16 v[32:47], v[232:235], v[116:119], v[32:47]
    s_andn2_b32 s55, s55, 8
    v_mfma_f32_32x32x16_bf16 v[48:63], v[252:255], v[124:127], v[48:63]
    v_mfma_f32_32x32x16_bf16 v[32:47], v[248:251], v[124:127], v[32:47]
    s_cbranch_scc1 L_o
L_od:
    s_nop 9
    ds_write_b128 v10, v[48:51] offset:0
    ds_write_b128 v10, v[52:55] offset:1024
    ds_write_b128 v10, v[56:59] offset:2048
    ds_write_b128 v10, v[60:63] offset:3072
    v_cmp_u_f32 vcc, v32, v48
    s_and_b64 vcc, vcc, s[32:33]
    s_cbranch_scc1 L_ox
    s_waitcnt lgkmcnt(0)
    s_barrier
L_s26:
    s_cbranch_execz L_t2r
    ds_read_b128 v[128:131], v11 offset:0
    ds_read_b128 v[132:135], v11 offset:1024
    ds_read_b128 v[136:139], v11 offset:2048
    ds_read_b128 v[140:143], v11 offset:3072
    s_waitcnt lgkmcnt(2)
    v_pk_add_f32 v[32:33], v[32:33], v[128:129]
    v_pk_add_f32 v[34:35], v[34:35], v[130:131]
    v_pk_add_f32 v[36:37], v[36:37], v[132:133]
    v_pk_add_f32 v[38:39], v[38:39], v[134:135]
    v_cvt_pk_bf16_f32 v16, v32, v33
    v_cvt_pk_bf16_f32 v17, v34, v35
    v_cvt_pk_bf16_f32 v18, v36, v37
    v_cvt_pk_bf16_f32 v19, v38, v39
    s_nop 0
    v_permlane32_swap_b32 v16, v18
    v_permlane32_swap_b32 v17, v19
    buffer_store_dwordx4 v[16:19], v9, s[64:67], s54 offen offset:0
    s_waitcnt lgkmcnt(0)
    v_pk_add_f32 v[40:41], v[40:41], v[136:137]
    v_pk_add_f32 v[42:43], v[42:43], v[138:139]
    v_pk_add_f32 v[44:45], v[44:45], v[140:141]
    v_pk_add_f32 v[46:47], v[46:47], v[142:143]
    v_cvt_pk_bf16_f32 v20, v40, v41
    v_cvt_pk_bf16_f32 v21, v42, v43
    v_cvt_pk_bf16_f32 v22, v44, v45
    v_cvt_pk_bf16_f32 v23, v46, v47
    s_nop 0
    v_permlane32_swap_b32 v20, v22
    v_permlane32_swap_b32 v21, v23
    buffer_store_dwordx4 v[20:23], v9, s[64:67], s54 offen offset:32
    s_waitcnt vmcnt(0)
    s_endpgm
L_ox:
    s_mov_b64 s[32:33], 0
    s_mov_b32 s62, 65536
    s_add_u32 s68, s68, 0x800000
    s_add_u32 s69, s69, 0x800000
    s_add_u32 s70, s70, 0x800000
    s_add_u32 s71, s71, 0x800000
    s_waitcnt vmcnt(0) lgkmcnt(0)
    s_nop 15
L_c00:
    buffer_load_dwordx4 v[64:67], v5, s[4:7], s68 offen offset:0 sc1
    buffer_load_dwordx4 v[72:75], v5, s[4:7], s68 offen offset:1024 sc1
    s_sub_u32 s62, s62, 1
    s_cselect_b32 s62, 0, s62
    s_waitcnt vmcnt(0)
    s_cbranch_scc1 L_cd00
    v_max3_u32 v13, v64, v65, v66
    v_max3_u32 v15, v72, v73, v74
    v_max3_u32 v13, v13, v67, v75
    v_max_u32 v13, v13, v15
    v_cmp_eq_u32 vcc, -1, v13
    s_sleep 2
    s_cbranch_vccnz L_c00
L_cd00:
    v_mfma_f32_32x32x16_bf16 v[48:63], v[132:135], v[64:67], 0
    v_mfma_f32_32x32x16_bf16 v[32:47], v[128:131], v[64:67], 0
    v_mfma_f32_32x32x16_bf16 v[48:63], v[148:151], v[72:75], v[48:63]
    v_mfma_f32_32x32x16_bf16 v[32:47], v[144:147], v[72:75], v[32:47]
L_c01:
    buffer_load_dwordx4 v[80:83], v5, s[4:7], s69 offen offset:0 sc1
    buffer_load_dwordx4 v[88:91], v5, s[4:7], s69 offen offset:1024 sc1
    s_sub_u32 s62, s62, 1
    s_cselect_b32 s62, 0, s62
    s_waitcnt vmcnt(0)
    s_cbranch_scc1 L_cd01
    v_max3_u32 v13, v80, v81, v82
    v_max3_u32 v15, v88, v89, v90
    v_max3_u32 v13, v13, v83, v91
    v_max_u32 v13, v13, v15
    v_cmp_eq_u32 vcc, -1, v13
    s_sleep 2
    s_cbranch_vccnz L_c01
L_cd01:
    v_mfma_f32_32x32x16_bf16 v[48:63], v[164:167], v[80:83], v[48:63]
    v_mfma_f32_32x32x16_bf16 v[32:47], v[160:163], v[80:83], v[32:47]
    v_mfma_f32_32x32x16_bf16 v[48:63], v[180:183], v[88:91], v[48:63]
    v_mfma_f32_32x32x16_bf16 v[32:47], v[176:179], v[88:91], v[32:47]
L_c02:
    buffer_load_dwordx4 v[96:99], v5, s[4:7], s70 offen offset:0 sc1
    buffer_load_dwordx4 v[104:107], v5, s[4:7], s70 offen offset:1024 sc1
    s_sub_u32 s62, s62, 1
    s_cselect_b32 s62, 0, s62
    s_waitcnt vmcnt(0)
    s_cbranch_scc1 L_cd02
    v_max3_u32 v13, v96, v97, v98
    v_max3_u32 v15, v104, v105, v106
    v_max3_u32 v13, v13, v99, v107
    v_max_u32 v13, v13, v15
    v_cmp_eq_u32 vcc, -1, v13
    s_sleep 2
    s_cbranch_vccnz L_c02
L_cd02:
    v_mfma_f32_32x32x16_bf16 v[48:63], v[196:199], v[96:99], v[48:63]
    v_mfma_f32_32x32x16_bf16 v[32:47], v[192:195], v[96:99], v[32:47]
    v_mfma_f32_32x32x16_bf16 v[48:63], v[212:215], v[104:107], v[48:63]
    v_mfma_f32_32x32x16_bf16 v[32:47], v[208:211], v[104:107], v[32:47]
L_c03:
    buffer_load_dwordx4 v[112:115], v5, s[4:7], s71 offen offset:0 sc1
    buffer_load_dwordx4 v[120:123], v5, s[4:7], s71 offen offset:1024 sc1
    s_sub_u32 s62, s62, 1
    s_cselect_b32 s62, 0, s62
    s_waitcnt vmcnt(0)
    s_cbranch_scc1 L_cd03
    v_max3_u32 v13, v112, v113, v114
    v_max3_u32 v15, v120, v121, v122
    v_max3_u32 v13, v13, v115, v123
    v_max_u32 v13, v13, v15
    v_cmp_eq_u32 vcc, -1, v13
    s_sleep 2
    s_cbranch_vccnz L_c03
L_cd03:
    v_mfma_f32_32x32x16_bf16 v[48:63], v[228:231], v[112:115], v[48:63]
    v_mfma_f32_32x32x16_bf16 v[32:47], v[224:227], v[112:115], v[32:47]
    v_mfma_f32_32x32x16_bf16 v[48:63], v[244:247], v[120:123], v[48:63]
    v_mfma_f32_32x32x16_bf16 v[32:47], v[240:243], v[120:123], v[32:47]
L_c10:
    buffer_load_dwordx4 v[68:71], v8, s[4:7], s68 offen offset:0 sc1
    buffer_load_dwordx4 v[76:79], v8, s[4:7], s68 offen offset:1024 sc1
    s_sub_u32 s62, s62, 1
    s_cselect_b32 s62, 0, s62
    s_waitcnt vmcnt(0)
    s_cbranch_scc1 L_cd10
    v_max3_u32 v13, v68, v69, v70
    v_max3_u32 v15, v76, v77, v78
    v_max3_u32 v13, v13, v71, v79
    v_max_u32 v13, v13, v15
    v_cmp_eq_u32 vcc, -1, v13
    s_sleep 2
    s_cbranch_vccnz L_c10
L_cd10:
    v_mfma_f32_32x32x16_bf16 v[48:63], v[140:143], v[68:71], v[48:63]
    v_mfma_f32_32x32x16_bf16 v[32:47], v[136:139], v[68:71], v[32:47]
    v_mfma_f32_32x32x16_bf16 v[48:63], v[156:159], v[76:79], v[48:63]
    v_mfma_f32_32x32x16_bf16 v[32:47], v[152:155], v[76:79], v[32:47]
L_c11:
    buffer_load_dwordx4 v[84:87], v8, s[4:7], s69 offen offset:0 sc1
    buffer_load_dwordx4 v[92:95], v8, s[4:7], s69 offen offset:1024 sc1
    s_sub_u32 s62, s62, 1
    s_cselect_b32 s62, 0, s62
    s_waitcnt vmcnt(0)
    s_cbranch_scc1 L_cd11
    v_max3_u32 v13, v84, v85, v86
    v_max3_u32 v15, v92, v93, v94
    v_max3_u32 v13, v13, v87, v95
    v_max_u32 v13, v13, v15
    v_cmp_eq_u32 vcc, -1, v13
    s_sleep 2
    s_cbranch_vccnz L_c11
L_cd11:
    v_mfma_f32_32x32x16_bf16 v[48:63], v[172:175], v[84:87], v[48:63]
    v_mfma_f32_32x32x16_bf16 v[32:47], v[168:171], v[84:87], v[32:47]
    v_mfma_f32_32x32x16_bf16 v[48:63], v[188:191], v[92:95], v[48:63]
    v_mfma_f32_32x32x16_bf16 v[32:47], v[184:187], v[92:95], v[32:47]
L_c12:
    buffer_load_dwordx4 v[100:103], v8, s[4:7], s70 offen offset:0 sc1
    buffer_load_dwordx4 v[108:111], v8, s[4:7], s70 offen offset:1024 sc1
    s_sub_u32 s62, s62, 1
    s_cselect_b32 s62, 0, s62
    s_waitcnt vmcnt(0)
    s_cbranch_scc1 L_cd12
    v_max3_u32 v13, v100, v101, v102
    v_max3_u32 v15, v108, v109, v110
    v_max3_u32 v13, v13, v103, v111
    v_max_u32 v13, v13, v15
    v_cmp_eq_u32 vcc, -1, v13
    s_sleep 2
    s_cbranch_vccnz L_c12
L_cd12:
    v_mfma_f32_32x32x16_bf16 v[48:63], v[204:207], v[100:103], v[48:63]
    v_mfma_f32_32x32x16_bf16 v[32:47], v[200:203], v[100:103], v[32:47]
    v_mfma_f32_32x32x16_bf16 v[48:63], v[220:223], v[108:111], v[48:63]
    v_mfma_f32_32x32x16_bf16 v[32:47], v[216:219], v[108:111], v[32:47]
L_c13:
    buffer_load_dwordx4 v[116:119], v8, s[4:7], s71 offen offset:0 sc1
    buffer_load_dwordx4 v[124:127], v8, s[4:7], s71 offen offset:1024 sc1
    s_sub_u32 s62, s62, 1
    s_cselect_b32 s62, 0, s62
    s_waitcnt vmcnt(0)
    s_cbranch_scc1 L_cd13
    v_max3_u32 v13, v116, v117, v118
    v_max3_u32 v15, v124, v125, v126
    v_max3_u32 v13, v13, v119, v127
    v_max_u32 v13, v13, v15
    v_cmp_eq_u32 vcc, -1, v13
    s_sleep 2
    s_cbranch_vccnz L_c13
L_cd13:
    v_mfma_f32_32x32x16_bf16 v[48:63], v[236:239], v[116:119], v[48:63]
    v_mfma_f32_32x32x16_bf16 v[32:47], v[232:235], v[116:119], v[32:47]
    v_mfma_f32_32x32x16_bf16 v[48:63], v[252:255], v[124:127], v[48:63]
    v_mfma_f32_32x32x16_bf16 v[32:47], v[248:251], v[124:127], v[32:47]
    s_branch L_od
L_fallback:
    v_mov_b32 v10, 0xff800000
    v_mov_b32 v11, 0xff800000
    s_mov_b32 s63, 0
L_fb1:
    s_lshr_b32 s54, s63, 2
    s_lshr_b32 s55, s63, 5
    s_lshl3_add_u32 s54, s55, s54
    s_mul_i32 s54, s54, 8704
    s_and_b32 s55, s63, 3
    s_lshl_b32 s55, s55, 10
    s_add_u32 s55, s55, s54
    s_add_u32 s56, s55, 4096
    s_add_u32 s63, s63, 1
    buffer_load_dwordx4 v[80:83], v5, s[4:7], s55 offen sc1
    s_waitcnt vmcnt(0)
    v_mfma_f32_32x32x16_bf16 v[48:63], v[80:83], v[24:27], 0
    v_mfma_f32_32x32x16_bf16 v[64:79], v[80:83], v[28:31], 0
    s_nop 11
    v_max3_f32 v10, v10, v48, v49
    v_max3_f32 v10, v10, v50, v51
    v_max3_f32 v10, v10, v52, v53
    v_max3_f32 v10, v10, v54, v55
    v_max3_f32 v10, v10, v56, v57
    v_max3_f32 v10, v10, v58, v59
    v_max3_f32 v10, v10, v60, v61
    v_max3_f32 v10, v10, v62, v63
    v_max3_f32 v11, v11, v64, v65
    v_max3_f32 v11, v11, v66, v67
    v_max3_f32 v11, v11, v68, v69
    v_max3_f32 v11, v11, v70, v71
    v_max3_f32 v11, v11, v72, v73
    v_max3_f32 v11, v11, v74, v75
    v_max3_f32 v11, v11, v76, v77
    v_max3_f32 v11, v11, v78, v79
    s_cmp_lg_u32 s63, 64
    s_cbranch_scc1 L_fb1
    v_mov_b32 v12, v10
    v_mov_b32 v13, v11
    s_nop 1
    v_permlane32_swap_b32 v10, v12
    v_permlane32_swap_b32 v11, v13
    v_max_f32 v10, v10, v12
    v_max_f32 v11, v11, v13
    v_pk_mov_b32 v[160:161], 0, 0
    v_pk_mov_b32 v[162:163], 0, 0
    v_pk_mov_b32 v[164:165], 0, 0
    v_pk_mov_b32 v[166:167], 0, 0
    v_pk_mov_b32 v[168:169], 0, 0
    v_pk_mov_b32 v[170:171], 0, 0
    v_pk_mov_b32 v[172:173], 0, 0
    v_pk_mov_b32 v[174:175], 0, 0
    v_pk_mov_b32 v[176:177], 0, 0
    v_pk_mov_b32 v[178:179], 0, 0
    v_pk_mov_b32 v[180:181], 0, 0
    v_pk_mov_b32 v[182:183], 0, 0
    v_pk_mov_b32 v[184:185], 0, 0
    v_pk_mov_b32 v[186:187], 0, 0
    v_pk_mov_b32 v[188:189], 0, 0
    v_pk_mov_b32 v[190:191], 0, 0
    s_mov_b32 s63, 0
L_fb2:
    s_lshr_b32 s54, s63, 2
    s_lshr_b32 s55, s63, 5
    s_lshl3_add_u32 s54, s55, s54
    s_mul_i32 s54, s54, 8704
    s_and_b32 s55, s63, 3
    s_lshl_b32 s55, s55, 10
    s_add_u32 s55, s55, s54
    s_add_u32 s56, s55, 4096
    s_add_u32 s63, s63, 1
    buffer_load_dwordx4 v[80:83], v5, s[4:7], s55 offen sc1
    s_mov_b64 exec, s[28:29]
    buffer_load_dwordx4 v[90:93], v5, s[4:7], s56 offen offset:0 sc1
    buffer_load_dwordx4 v[98:101], v5, s[4:7], s56 offen offset:256 sc1
    s_mov_b64 exec, -1
    s_waitcnt vmcnt(0)
    v_mfma_f32_32x32x16_bf16 v[48:63], v[80:83], v[24:27], 0
    v_mfma_f32_32x32x16_bf16 v[64:79], v[80:83], v[28:31], 0
    s_nop 11
    v_sub_f32 v48, v48, v10
    v_sub_f32 v49, v49, v10
    v_sub_f32 v50, v50, v10
    v_sub_f32 v51, v51, v10
    v_sub_f32 v52, v52, v10
    v_sub_f32 v53, v53, v10
    v_sub_f32 v54, v54, v10
    v_sub_f32 v55, v55, v10
    v_sub_f32 v56, v56, v10
    v_sub_f32 v57, v57, v10
    v_sub_f32 v58, v58, v10
    v_sub_f32 v59, v59, v10
    v_sub_f32 v60, v60, v10
    v_sub_f32 v61, v61, v10
    v_sub_f32 v62, v62, v10
    v_sub_f32 v63, v63, v10
    v_exp_f32 v48, v48
    v_exp_f32 v49, v49
    v_exp_f32 v50, v50
    v_exp_f32 v51, v51
    v_exp_f32 v52, v52
    v_exp_f32 v53, v53
    v_exp_f32 v54, v54
    v_exp_f32 v55, v55
    v_exp_f32 v56, v56
    v_exp_f32 v57, v57
    v_exp_f32 v58, v58
    v_exp_f32 v59, v59
    v_exp_f32 v60, v60
    v_exp_f32 v61, v61
    v_exp_f32 v62, v62
    v_exp_f32 v63, v63
    s_nop 1
    v_smfmac_f32_32x32x32_bf16 v[160:175], v[90:93], v[48:55], v9
    v_smfmac_f32_32x32x32_bf16 v[160:175], v[98:101], v[56:63], v9
    v_sub_f32 v64, v64, v11
    v_sub_f32 v65, v65, v11
    v_sub_f32 v66, v66, v11
    v_sub_f32 v67, v67, v11
    v_sub_f32 v68, v68, v11
    v_sub_f32 v69, v69, v11
    v_sub_f32 v70, v70, v11
    v_sub_f32 v71, v71, v11
    v_sub_f32 v72, v72, v11
    v_sub_f32 v73, v73, v11
    v_sub_f32 v74, v74, v11
    v_sub_f32 v75, v75, v11
    v_sub_f32 v76, v76, v11
    v_sub_f32 v77, v77, v11
    v_sub_f32 v78, v78, v11
    v_sub_f32 v79, v79, v11
    v_exp_f32 v64, v64
    v_exp_f32 v65, v65
    v_exp_f32 v66, v66
    v_exp_f32 v67, v67
    v_exp_f32 v68, v68
    v_exp_f32 v69, v69
    v_exp_f32 v70, v70
    v_exp_f32 v71, v71
    v_exp_f32 v72, v72
    v_exp_f32 v73, v73
    v_exp_f32 v74, v74
    v_exp_f32 v75, v75
    v_exp_f32 v76, v76
    v_exp_f32 v77, v77
    v_exp_f32 v78, v78
    v_exp_f32 v79, v79
    s_nop 1
    v_smfmac_f32_32x32x32_bf16 v[176:191], v[90:93], v[64:71], v9
    v_smfmac_f32_32x32x32_bf16 v[176:191], v[98:101], v[72:79], v9
    s_cmp_lg_u32 s63, 64
    s_nop 7
    s_cbranch_scc1 L_fb2
    s_nop 7
    v_rcp_f32 v10, v168
    v_rcp_f32 v12, v184
    s_nop 0
    v_pk_mul_f32 v[160:161], v[160:161], v[10:11] op_sel_hi:[1,0]
    v_pk_mul_f32 v[162:163], v[162:163], v[10:11] op_sel_hi:[1,0]
    v_pk_mul_f32 v[164:165], v[164:165], v[10:11] op_sel_hi:[1,0]
    v_pk_mul_f32 v[166:167], v[166:167], v[10:11] op_sel_hi:[1,0]
    v_cvt_pk_bf16_f32 v16, v160, v161
    v_cvt_pk_bf16_f32 v17, v162, v163
    v_cvt_pk_bf16_f32 v18, v164, v165
    v_cvt_pk_bf16_f32 v19, v166, v167
    buffer_store_dwordx4 v[16:19], v5, s[4:7], s64 offen
    buffer_store_dwordx4 v[16:19], v5, s[4:7], s66 offen sc1
    s_branch L_fin
.section .rodata,"a"
.p2align 6
.amdhsa_kernel concat_heads__grouped_kv_mqa__ssm_conv_s4d__prompt_kernel
  .amdhsa_next_free_vgpr 256
  .amdhsa_next_free_sgpr 102
  .amdhsa_accum_offset 256
  .amdhsa_group_segment_fixed_size 0
  .amdhsa_kernarg_size 120
  .amdhsa_user_sgpr_count 2
  .amdhsa_user_sgpr_kernarg_segment_ptr 1
  .amdhsa_system_sgpr_workgroup_id_x 1
.end_amdhsa_kernel
```
